```python
import torch

def _softmax(x, axis=-1):
    return torch.softmax(x, dim=axis)
def _gelu(x):
    return torch.nn.functional.gelu(x, approximate="tanh")
def _silu(x):
    return torch.nn.functional.silu(x)
def _sigmoid(x):
    return torch.sigmoid(x)
def _layernorm(x, axis=-1, eps=1e-5):
    m = x.mean(dim=axis, keepdim=True)
    v = x.var(dim=axis, keepdim=True, unbiased=False)
    return (x - m) / torch.sqrt(v + eps)
def _scatter_add(tgt, idx, src, axis=0):
    return tgt.clone().index_add_(axis, idx, src)
def _segment_sum(src, seg, n):
    out = torch.zeros((n,) + src.shape[1:], dtype=src.dtype)
    return out.index_add_(0, seg, src)
def _pad(x, pw):
    flat = tuple(v for pair in reversed(pw) for v in pair)
    return torch.nn.functional.pad(x, flat)

kernel_name = 'parallel_sum__ssm_conv_s4__glu_gated_reglu__prompt'

def setup_inputs():

    _w = (lambda a: (lambda t: t.to(torch.bfloat16) if t.is_floating_point() else t)(torch.as_tensor(a)))
    def _A_setup():
        B, L, D, N = 1, 2048, 448, 256
        A_re = -(lambda _x: torch.exp(torch.as_tensor(_x)))((lambda *s: torch.randn(*s, dtype=torch.bfloat16) * 6.4)(D, N))
        A_im = torch.pi * (lambda *s: torch.randn(*s, dtype=torch.bfloat16) * 0.05)(D, N)
        B_re = (lambda *s: torch.randn(*s, dtype=torch.bfloat16) * 0.1)(D, N)
        B_im = (lambda *s: torch.randn(*s, dtype=torch.bfloat16) * 0.1)(D, N)
        C_re = (lambda *s: torch.randn(*s, dtype=torch.bfloat16) * 0.1)(D, N)
        C_im = (lambda *s: torch.randn(*s, dtype=torch.bfloat16) * 0.1)(D, N)
        log_dt = (lambda *s: torch.randn(*s, dtype=torch.bfloat16) * 0.05)(D) * 0.5 - 4.0
        Dskip = (lambda *s: torch.randn(*s, dtype=torch.bfloat16) * 0.05)(D)
        return {
            "u": _w((lambda *s: torch.randn(*s, dtype=torch.bfloat16) * 0.05)(B, L, D)),
            "A_re": _w(A_re),
            "A_im": _w(A_im),
            "B_re": _w(B_re),
            "B_im": _w(B_im),
            "C_re": _w(C_re),
            "C_im": _w(C_im),
            "log_dt": _w(log_dt),
            "Dskip": _w(Dskip),
        }
    _A_in = _A_setup()

    def _B_setup():
        B, S, D, F = 1, 2048, 448, 1792
        return {
            "x": _w((lambda *s: torch.randn(*s, dtype=torch.bfloat16) * 0.05)(B, S, D)),
            "W_gate": _w((lambda *s: torch.randn(*s, dtype=torch.bfloat16) * 0.4)(D, F) * (2.0 / D) ** 0.5),
            "W_up": _w((lambda *s: torch.randn(*s, dtype=torch.bfloat16) * 0.4)(D, F) * (2.0 / D) ** 0.5),
            "W_down": _w((lambda *s: torch.randn(*s, dtype=torch.bfloat16) * 0.4)(F, D) * (1.0 / F) ** 0.5),
        }
    _B_in = _B_setup()

    return {
        "A_u": _A_in["u"],
        "A_A_re": _A_in["A_re"],
        "A_A_im": _A_in["A_im"],
        "A_B_re": _A_in["B_re"],
        "A_B_im": _A_in["B_im"],
        "A_C_re": _A_in["C_re"],
        "A_C_im": _A_in["C_im"],
        "A_log_dt": _A_in["log_dt"],
        "A_Dskip": _A_in["Dskip"],
        "B_x": _B_in["x"],
        "B_W_gate": _B_in["W_gate"],
        "B_W_up": _B_in["W_up"],
        "B_W_down": _B_in["W_down"],
    }

def reference(A_u, A_A_re, A_A_im, A_B_re, A_B_im, A_C_re, A_C_im, A_log_dt, A_Dskip, B_x, B_W_gate, B_W_up, B_W_down):
    def _A_ref(u, A_re, A_im, B_re, B_im, C_re, C_im, log_dt, Dskip):
        Bsz, L, D = u.shape
        dt = torch.exp(log_dt)[:, None]
        A = A_re + 1j * A_im
        Bc = B_re + 1j * B_im
        Cc = C_re + 1j * C_im
        logdA = dt * A
        dB = dt * Bc
        l = (lambda x, dt: x.to(dt))(torch.arange(L), A_re.dtype)
        P = torch.exp(logdA[:, :, None] * l[None, None, :])
        K = torch.einsum("dn,dnl,dn->dl", Cc, P, dB).real
        L2 = 2 * L
        Kp = _pad(K, ((0, 0), (0, L)))
        up = (lambda x, *d: x.permute(*d))(u, 0, 2, 1)
        up = _pad(up, ((0, 0), (0, 0), (0, L)))
        Kf = (lambda x, axes=(-2,-1): torch.fft.rfft2(x.float(), dim=axes))(Kp[:, None, :], axes=(-2, -1))
        Uf = (lambda x, axes=(-2,-1): torch.fft.rfft2(x.float(), dim=axes))(up[:, :, None, :], axes=(-2, -1))
        Yf = Uf * Kf[None, :, :, :]
        y = (lambda x, s, axes=(-2,-1): torch.fft.irfft2(x, s=s, dim=axes).to(torch.bfloat16))(Yf, (1, L2), axes=(-2, -1))[:, :, 0, :L]
        y = (lambda x, *d: x.permute(*d))(y, 0, 2, 1) + u * Dskip[None, None, :]
        return y

    def _B_ref(x, W_gate, W_up, W_down):
        gate = torch.einsum("bsd,df->bsf", x, W_gate)
        up = torch.einsum("bsd,df->bsf", x, W_up)
        gate = gate * (lambda x, dt: x.to(dt))(gate > 0, gate.dtype)
        h = gate * up
        return torch.einsum("bsf,fd->bsd", h, W_down)

    x = A_u
    xn = _layernorm(x, axis=-1)
    return x + _A_ref(xn, A_A_re, A_A_im, A_B_re, A_B_im, A_C_re, A_C_im, A_log_dt, A_Dskip) + _B_ref(xn, B_W_gate, B_W_up, B_W_down)
```

```asm
; @launch grid=(256,1,1) block=(256,1,1) lds=163840
.amdgcn_target "amdgcn-amd-amdhsa--gfx950"
.text
.globl parallel_sum__ssm_conv_s4__glu_gated_reglu__prompt_kernel
.p2align 8
.type parallel_sum__ssm_conv_s4__glu_gated_reglu__prompt_kernel,@function
parallel_sum__ssm_conv_s4__glu_gated_reglu__prompt_kernel:
    s_cmp_ge_u32 s2, 256
    s_cbranch_scc1 L_end
    s_load_dwordx16 s[4:19], s[0:1], 0
    s_load_dwordx16 s[20:35], s[0:1], 64
    s_getpc_b64 s[70:71]
L_pc:
    s_and_b32 s57, s2, 7
    s_lshr_b32 s58, s2, 3
    v_lshrrev_b32_e64 v1, 6, v0
    v_and_b32 v255, 63, v0
    v_readfirstlane_b32 s56, v1
    s_and_b32 s69, s58, 3
    s_lshl_b32 s74, s69, 6
    v_lshl_add_u32 v2, v1, 4, v255
    v_add_u32_e64 v2, s74, v2
    v_lshlrev_b32 v2, 7, v2
    v_min_u32 v2, L_codeend-L_pc-4, v2
    s_mov_b64 exec, 0xffff
    global_load_dword v253, v2, s[70:71]
    s_mov_b64 exec, -1
    s_mov_b32 s38, 1835008
    s_mov_b32 s39, 0x20000
    s_mov_b32 s42, 1605632
    s_mov_b32 s43, 0x20000
    s_mov_b32 s50, 12058624
    s_mov_b32 s51, 0x20000
    v_lshlrev_b32_e64 v250, 4, v255
    s_mov_b32 s78, 0xffff0000
    s_cmp_lt_u32 s58, 4
    s_cbranch_scc1 L_helper
    s_sub_u32 s58, s58, 4
    s_mul_i32 s74, s57, 28
    s_add_u32 s61, s74, s58
    s_lshl_b32 s74, s61, 10
    s_lshl_b32 s75, s56, 8
    s_add_u32 s74, s74, s75
    v_lshl_add_u32 v4, v255, 2, s74
    s_lshr_b32 s79, s74, 9
    s_lshl_b32 s74, s79, 1
    v_mov_b32_e64 v5, s74
    s_lshr_b32 s63, s58, 2
    s_lshr_b32 s74, s57, 1
    s_lshl_b32 s74, s74, 2
    s_add_u32 s59, s74, s69
    s_lshl_b32 s81, s59, 2
    s_add_u32 s81, s81, s56
    s_mul_i32 s72, s81, 28672
    s_lshl_b32 s73, s56, 12
    s_and_b32 s74, s57, 1
    s_mul_i32 s74, s74, 7
    s_add_u32 s60, s74, s63
    s_lshl_b32 s65, s60, 8
    s_lshr_b32 s84, s56, 1
    s_and_b32 s85, s56, 1
    s_lshl_b32 s74, s85, 13
    s_lshl_b32 s75, s84, 12
    s_add_u32 s77, s74, s75
    v_and_b32_e64 v220, 3, v255
    v_bfe_u32 v221, v255, 2, 2
    v_lshrrev_b32 v222, 5, v255
    v_lshrrev_b32 v223, 4, v255
    v_and_b32 v226, 1, v223
    v_lshrrev_b32 v6, 3, v255
    v_mul_u32_u24 v1, 896, v6
    v_and_b32 v2, 7, v255
    v_xor_b32 v2, v2, v223
    v_lshl_add_u32 v180, v2, 4, v1
    v_xor_b32_e64 v181, 64, v180
    v_add_u32 v181, 6144, v181
    v_add_u32 v182, 12288, v180
    v_add_u32 v183, 12288, v181
    s_lshl_b32 s74, s84, 4
    v_add_u32 v1, s74, v221
    v_mul_u32_u24 v1, 3584, v1
    v_lshl_add_u32 v1, v223, 6, v1
    s_lshl_b32 s76, s85, 1
    v_xor_b32 v2, s76, v220
    v_lshl_add_u32 v184, v2, 4, v1
    v_add_u32 v185, 13312, v184
    v_add_u32 v186, 26624, v184
    v_add_u32 v187, 39936, v184
    s_waitcnt lgkmcnt(0)
    global_load_ushort v134, v5, s[18:19]
    global_load_dword v128, v4, s[6:7]
    global_load_dword v129, v4, s[8:9]
    global_load_dword v130, v4, s[10:11]
    global_load_dword v131, v4, s[12:13]
    global_load_dword v132, v4, s[14:15]
    global_load_dword v133, v4, s[16:17]
    global_load_ushort v135, v5, s[20:21]
    s_mov_b32 s36, s4
    s_mov_b32 s37, s5
    s_bitcmp1_b32 s56, 0
    s_cselect_b32 s40, s26, s24
    s_cselect_b32 s41, s27, s25
    s_cselect_b64 s[22:23], -1, 0
    s_add_u32 m0, s73, 32768
    s_nop 0
    buffer_load_dwordx4 v180, s[36:39], s72 offen  lds
    buffer_load_dwordx4 v181, s[36:39], s72 offen offset:1024  lds
    buffer_load_dwordx4 v182, s[36:39], s72 offen offset:2048  lds
    buffer_load_dwordx4 v183, s[36:39], s72 offen offset:3072  lds
    s_add_u32 s72, s72, 128
    s_add_u32 m0, s77, 0
    s_nop 0
    buffer_load_dwordx4 v184, s[40:43], s65 offen  lds
    buffer_load_dwordx4 v185, s[40:43], s65 offen offset:1024  lds
    buffer_load_dwordx4 v186, s[40:43], s65 offen offset:2048  lds
    buffer_load_dwordx4 v187, s[40:43], s65 offen offset:3072  lds
    s_add_u32 s65, s65, 114688
    s_add_u32 s74, s73, 147456
    v_add_u32_e64 v170, s74, v250
    v_xor_b32 v171, 4096, v170
    v_bfe_u32 v1, v255, 1, 2
    v_lshlrev_b32_e64 v7, 4, v1
    v_lshl_add_u32 v7, v255, 6, v7
    v_add_u32 v190, s74, v7
    v_xor_b32 v191, 16, v190
    v_xor_b32 v192, 32, v190
    v_xor_b32 v193, 48, v190
    v_lshl_add_u32 v7, v222, 3, v221
    v_lshlrev_b32_e64 v7, 6, v7
    v_bfe_u32 v8, v255, 1, 1
    v_lshl_add_u32 v8, v226, 1, v8
    v_lshrrev_b32 v9, 1, v221
    v_xor_b32 v8, v8, v9
    v_lshl_add_u32 v7, v8, 4, v7
    v_and_b32_e64 v10, 1, v255
    v_lshl_add_u32 v7, v10, 3, v7
    v_add_u32 v194, s74, v7
    v_xor_b32 v195, 32, v194
    v_add_u32 v195, 256, v195
    s_lshl_b32 s76, s85, 5
    v_xor_b32 v196, s76, v194
    v_xor_b32 v197, s76, v195
    v_and_b32 v11, 31, v255
    v_bfe_u32 v12, v255, 1, 3
    v_xor_b32 v7, v12, v222
    v_lshlrev_b32 v7, 4, v7
    v_lshl_add_u32 v7, v11, 7, v7
    s_and_b32 s74, s73, 8192
    s_add_u32 s74, s74, 32768
    v_add_u32 v172, s74, v7
    v_xor_b32 v173, 32, v172
    v_xor_b32_e64 v174, 64, v172
    v_xor_b32 v175, 96, v172
    v_add_u32 v176, 0x10000, v172
    v_add_u32 v177, 0x10000, v173
    v_add_u32 v178, 0x10000, v174
    v_add_u32 v179, 0x10000, v175
    v_lshlrev_b32_e64 v13, 3, v220
    v_lshl_add_u32 v13, v221, 6, v13
    v_mul_u32_u24 v7, 8224, v226
    v_lshl_add_u32 v7, v222, 11, v7
    s_mul_i32 s74, s85, 512
    v_add3_u32 v188, v7, v13, s74
    v_xor_b32_e64 v189, 32, v188
    v_lshl_add_u32 v7, v226, 5, v13
    v_lshl_add_u32 v7, v222, 9, v7
    s_lshl_b32 s74, s85, 8
    s_add_u32 s74, s74, s73
    s_add_u32 s74, s74, 65536
    v_add_u32_e64 v204, s74, v7
    v_xor_b32 v205, 256, v204
    v_add_u32 v206, 0x10000, v204
    v_add_u32 v207, 0x10000, v205
    s_mul_i32 s74, s56, 448
    v_lshl_add_u32 v7, v222, 2, v221
    v_add_u32_e64 v7, s74, v7
    v_mul_u32_u24 v7, 896, v7
    v_lshl_add_u32 v7, v226, 6, v7
    v_lshl_add_u32 v200, v220, 4, v7
    v_add_u32 v201, 6144, v200
    v_add_u32 v202, 12288, v200
    v_add_u32 v203, 18432, v200
    v_lshlrev_b32 v210, 2, v11
    v_lshlrev_b32 v211, 3, v11
    s_mul_i32 s88, s84, 16656
    s_add_u32 s88, s88, 16
    s_lshl_b32 s74, s85, 10
    s_sub_u32 s74, s88, s74
    s_add_u32 s74, s74, 4068
    v_sub_u32 v160, s74, v250
    v_add_u32 v161, 4164, v160
    v_add_u32 v162, 8328, v160
    v_add_u32 v163, 12492, v160
    v_lshlrev_b32 v7, 9, v222
    v_sub_u32 v7, v160, v7
    s_mul_i32 s74, s85, 1536
    s_sub_u32 s74, 2560, s74
    v_subrev_u32_e64 v164, s74, v7
    v_add_u32 v165, 4164, v164
    v_add_u32 v166, 8328, v164
    v_add_u32 v167, 12492, v164
    v_and_b32_e64 v11, 15, v255
    v_mul_u32_u24 v7, 4164, v223
    v_lshl_add_u32 v7, v11, 2, v7
    v_add_u32 v168, s88, v7
    v_lshlrev_b32 v7, 2, v11
    v_lshlrev_b32_e64 v212, 2, v210
    v_min_u32 v7, 108, v210
    v_mul_u32_u24 v8, 1024, v222
    v_add_u32_e64 v217, v7, v8
    s_mul_i32 s75, s84, 9280
    s_add_u32 s75, s75, 33536
    s_mul_i32 s74, s85, 4640
    s_add_u32 s74, s74, s75
    v_min_u32_e64 v7, 55, v255
    v_lshl_add_u32 v169, v7, 3, s74
    s_lshl_b32 s74, s85, 11
    s_add_u32 s82, s75, s74
    s_mul_i32 s83, s79, 4224
    s_add_u32 s83, s83, s74
    s_add_u32 s83, s83, 7340032
    v_mul_u32_u24 v7, 4640, v10
    v_lshl_add_u32 v7, v12, 6, v7
    v_lshl_add_u32 v7, v223, 4, v7
    s_lshl_b32 s74, s85, 6
    s_sub_u32 s75, s75, s74
    s_add_u32 s75, s75, 64
    v_add_u32 v208, s75, v7
    v_mul_u32_u24 v7, 4160, v220
    v_sub_u32 v8, v223, v221
    v_lshl_add_u32 v7, v8, 4, v7
    s_sub_u32 s74, s88, s74
    s_add_u32 s74, s74, 112
    v_add_u32 v209, s74, v7
    s_lshl_b32 s74, s56, 10
    s_add_u32 s74, s74, 32768
    v_add_u32 v214, s74, v250
    v_lshlrev_b32 v7, 8, v1
    v_lshl_add_u32 v7, v6, 5, v7
    v_lshl_add_u32 v7, v10, 3, v7
    s_lshl_b32 s74, s56, 13
    s_add_u32 s75, s74, 36864
    v_add_u32 v215, s75, v7
    s_add_u32 s74, s74, 8192
    s_and_b32 s74, s74, 0x7fff
    s_add_u32 s74, s74, 32768
    v_add_u32_e64 v216, s74, v7
    s_mul_i32 s74, s84, 114688
    v_add_u32_e64 v218, s74, v250
    s_sub_u32 s74, 114688, s74
    v_add_u32 v219, s74, v250
    v_mov_b32 v225, 0
    s_lshl_b32 s74, s57, 2
    s_add_u32 s62, s74, s69
    s_lshl_b32 s74, s62, 1
    s_add_u32 s74, s74, s84
    s_lshl_b32 s97, s74, 5
    s_lshl_b32 s74, s63, 1
    s_add_u32 s74, s74, s85
    s_lshl_b32 s17, s74, 6
    s_mul_i32 s74, s97, 896
    s_add_u32 s16, s74, s17
    v_lshrrev_b32 v7, 2, v255
    v_mul_u32_u24 v7, 896, v7
    v_xor_b32_e64 v8, v220, v223
    v_lshl_add_u32 v227, v8, 4, v7
    s_waitcnt vmcnt(15)
    v_lshlrev_b32 v134, 16, v134
    v_mul_f32 v134, 0x3fb8aa3b, v134
    v_exp_f32 v134, v134
    s_nop 0
    v_cvt_pk_bf16_f32 v134, v134, v134
    v_lshlrev_b32 v134, 16, v134
    s_waitcnt vmcnt(14)
    v_lshlrev_b32_e64 v136, 16, v128
    s_add_u32 m0, s73, 49152
    s_waitcnt vmcnt(13)
    v_lshlrev_b32 v137, 16, v129
    s_waitcnt vmcnt(12)
    v_lshlrev_b32 v138, 16, v130
    s_waitcnt vmcnt(11)
    v_lshlrev_b32 v139, 16, v131
    s_waitcnt vmcnt(10)
    v_lshlrev_b32 v140, 16, v132
    s_waitcnt vmcnt(9)
    v_lshlrev_b32 v141, 16, v133
    v_mul_f32 v142, v134, v136
    v_mul_f32 v143, v134, v137
    v_mul_f32 v142, 0x3fb8aa3b, v142
    v_mul_f32_e64 v143, 0.15915494, v143
    buffer_load_dwordx4 v180, s[36:39], s72 offen  lds
    v_exp_f32 v144, v142
    v_fract_f32 v145, v143
    v_cos_f32 v146, v145
    v_sin_f32 v147, v145
    v_pk_mul_f32 v[2:3], v[140:141], v[138:139] op_sel_hi:[1,0]
    v_pk_mul_f32 v[146:147], v[146:147], v[144:145] op_sel_hi:[1,0]
    v_mul_f32 v144, 0x41000000, v142
    v_mul_f32 v145, 0x41000000, v143
    v_exp_f32 v144, v144
    v_fract_f32 v145, v145
    buffer_load_dwordx4 v181, s[36:39], s72 offen offset:1024  lds
    v_cos_f32 v148, v145
    v_sin_f32 v149, v145
    v_pk_fma_f32 v[8:9], v[140:141], v[138:139], v[2:3] op_sel:[1,1,0] op_sel_hi:[0,1,1] neg_lo:[1,0,0]
    v_pk_mul_f32 v[148:149], v[148:149], v[144:145] op_sel_hi:[1,0]
    v_mul_f32 v144, 0x43800000, v142
    v_mul_f32 v145, 0x43800000, v143
    v_exp_f32 v144, v144
    v_fract_f32 v145, v145
    v_cos_f32_e64 v0, v145
    v_sin_f32 v1, v145
    buffer_load_dwordx4 v182, s[36:39], s72 offen offset:2048  lds
    s_waitcnt vmcnt(11)
    v_pk_mul_f32 v[8:9], v[8:9], v[134:135] op_sel_hi:[1,0]
    v_pk_mul_f32 v[0:1], v[0:1], v[144:145] op_sel_hi:[1,0]
    v_pk_mul_f32 v[2:3], v[8:9], v[146:147] op_sel_hi:[1,0]
    v_pk_fma_f32 v[10:11], v[8:9], v[146:147], v[2:3] op_sel:[1,1,0] op_sel_hi:[0,1,1] neg_lo:[1,0,0]
    v_pk_mul_f32 v[2:3], v[10:11], v[146:147] op_sel_hi:[1,0]
    v_pk_fma_f32 v[12:13], v[10:11], v[146:147], v[2:3] op_sel:[1,1,0] op_sel_hi:[0,1,1] neg_lo:[1,0,0]
    v_pk_mul_f32 v[2:3], v[12:13], v[146:147] op_sel_hi:[1,0]
    v_pk_fma_f32 v[14:15], v[12:13], v[146:147], v[2:3] op_sel:[1,1,0] op_sel_hi:[0,1,1] neg_lo:[1,0,0]
    v_pk_mul_f32 v[2:3], v[14:15], v[146:147] op_sel_hi:[1,0]
    v_pk_fma_f32 v[16:17], v[14:15], v[146:147], v[2:3] op_sel:[1,1,0] op_sel_hi:[0,1,1] neg_lo:[1,0,0]
    buffer_load_dwordx4 v183, s[36:39], s72 offen offset:3072  lds
    v_pk_mul_f32 v[2:3], v[16:17], v[146:147] op_sel_hi:[1,0]
    v_pk_fma_f32 v[18:19], v[16:17], v[146:147], v[2:3] op_sel:[1,1,0] op_sel_hi:[0,1,1] neg_lo:[1,0,0]
    v_pk_mul_f32 v[2:3], v[18:19], v[146:147] op_sel_hi:[1,0]
    v_pk_fma_f32 v[20:21], v[18:19], v[146:147], v[2:3] op_sel:[1,1,0] op_sel_hi:[0,1,1] neg_lo:[1,0,0]
    v_pk_mul_f32 v[2:3], v[20:21], v[146:147] op_sel_hi:[1,0]
    v_pk_fma_f32 v[22:23], v[20:21], v[146:147], v[2:3] op_sel:[1,1,0] op_sel_hi:[0,1,1] neg_lo:[1,0,0]
    v_pk_mul_f32 v[2:3], v[22:23], v[146:147] op_sel_hi:[1,0]
    v_pk_fma_f32 v[24:25], v[22:23], v[146:147], v[2:3] op_sel:[1,1,0] op_sel_hi:[0,1,1] neg_lo:[1,0,0]
    v_pk_mul_f32 v[2:3], v[8:9], v[0:1] op_sel_hi:[1,0]
    v_pk_fma_f32 v[26:27], v[8:9], v[0:1], v[2:3] op_sel:[1,1,0] op_sel_hi:[0,1,1] neg_lo:[1,0,0]
    s_add_u32 s72, s72, 128
    v_pk_mul_f32 v[2:3], v[12:13], v[0:1] op_sel_hi:[1,0]
    v_pk_fma_f32 v[28:29], v[12:13], v[0:1], v[2:3] op_sel:[1,1,0] op_sel_hi:[0,1,1] neg_lo:[1,0,0]
    v_pk_mul_f32 v[2:3], v[16:17], v[0:1] op_sel_hi:[1,0]
    v_pk_fma_f32 v[30:31], v[16:17], v[0:1], v[2:3] op_sel:[1,1,0] op_sel_hi:[0,1,1] neg_lo:[1,0,0]
    v_pk_mul_f32 v[2:3], v[20:21], v[0:1] op_sel_hi:[1,0]
    v_pk_fma_f32 v[32:33], v[20:21], v[0:1], v[2:3] op_sel:[1,1,0] op_sel_hi:[0,1,1] neg_lo:[1,0,0]
    v_pk_mul_f32 v[2:3], v[24:25], v[0:1] op_sel_hi:[1,0]
    v_pk_fma_f32 v[34:35], v[24:25], v[0:1], v[2:3] op_sel:[1,1,0] op_sel_hi:[0,1,1] neg_lo:[1,0,0]
    v_pk_mul_f32 v[2:3], v[26:27], v[0:1] op_sel_hi:[1,0]
    v_pk_fma_f32 v[36:37], v[26:27], v[0:1], v[2:3] op_sel:[1,1,0] op_sel_hi:[0,1,1] neg_lo:[1,0,0]
    s_add_u32 m0, s77, 16384
    v_pk_mul_f32 v[2:3], v[30:31], v[0:1] op_sel_hi:[1,0]
    v_pk_fma_f32 v[38:39], v[30:31], v[0:1], v[2:3] op_sel:[1,1,0] op_sel_hi:[0,1,1] neg_lo:[1,0,0]
    v_pk_mul_f32 v[2:3], v[34:35], v[0:1] op_sel_hi:[1,0]
    v_pk_fma_f32 v[40:41], v[34:35], v[0:1], v[2:3] op_sel:[1,1,0] op_sel_hi:[0,1,1] neg_lo:[1,0,0]
    v_pk_mul_f32 v[2:3], v[36:37], v[0:1] op_sel_hi:[1,0]
    v_pk_fma_f32 v[42:43], v[36:37], v[0:1], v[2:3] op_sel:[1,1,0] op_sel_hi:[0,1,1] neg_lo:[1,0,0]
    v_pk_mul_f32 v[2:3], v[38:39], v[0:1] op_sel_hi:[1,0]
    v_pk_fma_f32 v[44:45], v[38:39], v[0:1], v[2:3] op_sel:[1,1,0] op_sel_hi:[0,1,1] neg_lo:[1,0,0]
    v_pk_mul_f32 v[2:3], v[40:41], v[0:1] op_sel_hi:[1,0]
    buffer_load_dwordx4 v184, s[40:43], s65 offen  lds
    v_pk_fma_f32 v[46:47], v[40:41], v[0:1], v[2:3] op_sel:[1,1,0] op_sel_hi:[0,1,1] neg_lo:[1,0,0]
    v_pk_mul_f32 v[2:3], v[42:43], v[0:1] op_sel_hi:[1,0]
    v_pk_fma_f32 v[48:49], v[42:43], v[0:1], v[2:3] op_sel:[1,1,0] op_sel_hi:[0,1,1] neg_lo:[1,0,0]
    v_pk_mul_f32 v[2:3], v[46:47], v[0:1] op_sel_hi:[1,0]
    v_pk_fma_f32 v[50:51], v[46:47], v[0:1], v[2:3] op_sel:[1,1,0] op_sel_hi:[0,1,1] neg_lo:[1,0,0]
    v_pk_mul_f32 v[2:3], v[48:49], v[0:1] op_sel_hi:[1,0]
    v_pk_fma_f32 v[52:53], v[48:49], v[0:1], v[2:3] op_sel:[1,1,0] op_sel_hi:[0,1,1] neg_lo:[1,0,0]
    v_pk_mul_f32 v[2:3], v[50:51], v[0:1] op_sel_hi:[1,0]
    v_pk_fma_f32 v[54:55], v[50:51], v[0:1], v[2:3] op_sel:[1,1,0] op_sel_hi:[0,1,1] neg_lo:[1,0,0]
    v_pk_mul_f32 v[2:3], v[52:53], v[0:1] op_sel_hi:[1,0]
    buffer_load_dwordx4 v185, s[40:43], s65 offen offset:1024  lds
    v_pk_fma_f32 v[56:57], v[52:53], v[0:1], v[2:3] op_sel:[1,1,0] op_sel_hi:[0,1,1] neg_lo:[1,0,0]
    v_pk_mul_f32 v[2:3], v[54:55], v[0:1] op_sel_hi:[1,0]
    v_pk_fma_f32 v[58:59], v[54:55], v[0:1], v[2:3] op_sel:[1,1,0] op_sel_hi:[0,1,1] neg_lo:[1,0,0]
    v_pk_mul_f32 v[2:3], v[56:57], v[0:1] op_sel_hi:[1,0]
    v_pk_fma_f32 v[60:61], v[56:57], v[0:1], v[2:3] op_sel:[1,1,0] op_sel_hi:[0,1,1] neg_lo:[1,0,0]
    v_pk_mul_f32 v[2:3], v[58:59], v[0:1] op_sel_hi:[1,0]
    v_pk_fma_f32 v[62:63], v[58:59], v[0:1], v[2:3] op_sel:[1,1,0] op_sel_hi:[0,1,1] neg_lo:[1,0,0]
    v_cvt_pk_bf16_f32 v64, v8, v10
    v_cvt_pk_bf16_f32 v80, -v9, -v11
    v_cvt_pk_bf16_f32 v65, v12, v14
    buffer_load_dwordx4 v186, s[40:43], s65 offen offset:2048  lds
    v_cvt_pk_bf16_f32 v81, -v13, -v15
    v_cvt_pk_bf16_f32 v66, v26, v26
    v_cvt_pk_bf16_f32 v82, -v27, -v27
    v_cvt_pk_bf16_f32 v67, v28, v30
    v_cvt_pk_bf16_f32 v83, -v29, -v31
    v_cvt_pk_bf16_f32 v68, v16, v18
    v_cvt_pk_bf16_f32 v84, -v17, -v19
    v_cvt_pk_bf16_f32 v69, v20, v22
    v_cvt_pk_bf16_f32 v85, -v21, -v23
    v_cvt_pk_bf16_f32 v70, v30, v30
    buffer_load_dwordx4 v187, s[40:43], s65 offen offset:3072  lds
    v_cvt_pk_bf16_f32 v86, -v31, -v31
    v_cvt_pk_bf16_f32 v71, v32, v34
    v_cvt_pk_bf16_f32 v87, -v33, -v35
    v_cvt_pk_bf16_f32 v72, v36, v38
    v_cvt_pk_bf16_f32 v88, -v37, -v39
    v_cvt_pk_bf16_f32 v73, v40, v48
    v_cvt_pk_bf16_f32 v89, -v41, -v49
    v_cvt_pk_bf16_f32 v74, v42, v44
    v_cvt_pk_bf16_f32 v90, -v43, -v45
    v_cvt_pk_bf16_f32 v75, v46, v56
    s_add_u32 s65, s65, 114688
    v_cvt_pk_bf16_f32 v91, -v47, -v57
    v_cvt_pk_bf16_f32 v76, v50, v52
    v_cvt_pk_bf16_f32 v92, -v51, -v53
    v_cvt_pk_bf16_f32 v77, v54, v54
    v_cvt_pk_bf16_f32 v93, -v55, -v55
    v_cvt_pk_bf16_f32 v78, v58, v60
    v_cvt_pk_bf16_f32 v94, -v59, -v61
    v_cvt_pk_bf16_f32 v79, v62, v62
    v_cvt_pk_bf16_f32 v95, -v63, -v63
    v_and_b32_e64 v136, s78, v128
    s_cmp_eq_u32 s56, 0
    s_cselect_b32 s12, s24, s26
    s_cselect_b32 s13, s25, s27
    s_cmp_lt_u32 s56, 2
    s_cselect_b32 s12, s12, s28
    s_cselect_b32 s13, s13, s29
    s_mul_i32 s74, s61, 7168
    v_min_u32_e64 v251, 55, v255
    v_lshl_add_u32 v251, v251, 7, s74
    global_load_dword v252, v251, s[12:13]
    v_and_b32 v137, s78, v129
    v_and_b32 v138, s78, v130
    v_and_b32 v139, s78, v131
    v_and_b32 v140, s78, v132
    v_and_b32 v141, s78, v133
    v_mul_f32 v142, v134, v136
    v_mul_f32_e64 v143, v134, v137
    v_mul_f32 v142, 0x3fb8aa3b, v142
    v_mul_f32 v143, 0.15915494, v143
    v_exp_f32 v144, v142
    v_fract_f32 v145, v143
    v_cos_f32 v146, v145
    v_sin_f32_e64 v147, v145
    v_pk_mul_f32 v[2:3], v[140:141], v[138:139] op_sel_hi:[1,0]
    v_pk_mul_f32 v[146:147], v[146:147], v[144:145] op_sel_hi:[1,0]
    v_mul_f32 v144, 0x41000000, v142
    v_mul_f32 v145, 0x41000000, v143
    v_exp_f32 v144, v144
    v_fract_f32 v145, v145
    v_cos_f32 v150, v145
    v_sin_f32 v151, v145
    v_pk_fma_f32 v[8:9], v[140:141], v[138:139], v[2:3] op_sel:[1,1,0] op_sel_hi:[0,1,1] neg_lo:[1,0,0]
    v_pk_mul_f32 v[150:151], v[150:151], v[144:145] op_sel_hi:[1,0]
    v_mul_f32 v144, 0x43800000, v142
    v_mul_f32 v145, 0x43800000, v143
    v_exp_f32 v144, v144
    v_fract_f32 v145, v145
    v_cos_f32 v0, v145
    v_sin_f32 v1, v145
    v_pk_mul_f32 v[8:9], v[8:9], v[134:135] op_sel_hi:[1,0]
    v_pk_mul_f32 v[0:1], v[0:1], v[144:145] op_sel_hi:[1,0]
    v_pk_mul_f32 v[2:3], v[8:9], v[146:147] op_sel_hi:[1,0]
    v_pk_fma_f32 v[10:11], v[8:9], v[146:147], v[2:3] op_sel:[1,1,0] op_sel_hi:[0,1,1] neg_lo:[1,0,0]
    v_pk_mul_f32 v[2:3], v[10:11], v[146:147] op_sel_hi:[1,0]
    v_pk_fma_f32 v[12:13], v[10:11], v[146:147], v[2:3] op_sel:[1,1,0] op_sel_hi:[0,1,1] neg_lo:[1,0,0]
    v_pk_mul_f32 v[2:3], v[12:13], v[146:147] op_sel_hi:[1,0]
    v_pk_fma_f32 v[14:15], v[12:13], v[146:147], v[2:3] op_sel:[1,1,0] op_sel_hi:[0,1,1] neg_lo:[1,0,0]
    v_pk_mul_f32 v[2:3], v[14:15], v[146:147] op_sel_hi:[1,0]
    v_pk_fma_f32 v[16:17], v[14:15], v[146:147], v[2:3] op_sel:[1,1,0] op_sel_hi:[0,1,1] neg_lo:[1,0,0]
    buffer_load_dwordx4 v[242:245], v227, s[36:39], s16 offen
    v_pk_mul_f32 v[2:3], v[16:17], v[146:147] op_sel_hi:[1,0]
    v_pk_fma_f32 v[18:19], v[16:17], v[146:147], v[2:3] op_sel:[1,1,0] op_sel_hi:[0,1,1] neg_lo:[1,0,0]
    v_pk_mul_f32 v[2:3], v[18:19], v[146:147] op_sel_hi:[1,0]
    v_pk_fma_f32 v[20:21], v[18:19], v[146:147], v[2:3] op_sel:[1,1,0] op_sel_hi:[0,1,1] neg_lo:[1,0,0]
    v_pk_mul_f32 v[2:3], v[20:21], v[146:147] op_sel_hi:[1,0]
    v_pk_fma_f32 v[22:23], v[20:21], v[146:147], v[2:3] op_sel:[1,1,0] op_sel_hi:[0,1,1] neg_lo:[1,0,0]
    v_pk_mul_f32 v[2:3], v[22:23], v[146:147] op_sel_hi:[1,0]
    v_pk_fma_f32 v[24:25], v[22:23], v[146:147], v[2:3] op_sel:[1,1,0] op_sel_hi:[0,1,1] neg_lo:[1,0,0]
    v_pk_mul_f32 v[2:3], v[8:9], v[0:1] op_sel_hi:[1,0]
    v_pk_fma_f32 v[26:27], v[8:9], v[0:1], v[2:3] op_sel:[1,1,0] op_sel_hi:[0,1,1] neg_lo:[1,0,0]
    v_pk_mul_f32 v[2:3], v[12:13], v[0:1] op_sel_hi:[1,0]
    v_pk_fma_f32 v[28:29], v[12:13], v[0:1], v[2:3] op_sel:[1,1,0] op_sel_hi:[0,1,1] neg_lo:[1,0,0]
    v_pk_mul_f32 v[2:3], v[16:17], v[0:1] op_sel_hi:[1,0]
    v_pk_fma_f32 v[30:31], v[16:17], v[0:1], v[2:3] op_sel:[1,1,0] op_sel_hi:[0,1,1] neg_lo:[1,0,0]
    v_pk_mul_f32 v[2:3], v[20:21], v[0:1] op_sel_hi:[1,0]
    v_pk_fma_f32 v[32:33], v[20:21], v[0:1], v[2:3] op_sel:[1,1,0] op_sel_hi:[0,1,1] neg_lo:[1,0,0]
    v_pk_mul_f32 v[2:3], v[24:25], v[0:1] op_sel_hi:[1,0]
    v_pk_fma_f32 v[34:35], v[24:25], v[0:1], v[2:3] op_sel:[1,1,0] op_sel_hi:[0,1,1] neg_lo:[1,0,0]
    v_pk_mul_f32 v[2:3], v[26:27], v[0:1] op_sel_hi:[1,0]
    v_pk_fma_f32 v[36:37], v[26:27], v[0:1], v[2:3] op_sel:[1,1,0] op_sel_hi:[0,1,1] neg_lo:[1,0,0]
    v_pk_mul_f32 v[2:3], v[30:31], v[0:1] op_sel_hi:[1,0]
    v_pk_fma_f32 v[38:39], v[30:31], v[0:1], v[2:3] op_sel:[1,1,0] op_sel_hi:[0,1,1] neg_lo:[1,0,0]
    v_pk_mul_f32 v[2:3], v[34:35], v[0:1] op_sel_hi:[1,0]
    v_pk_fma_f32 v[40:41], v[34:35], v[0:1], v[2:3] op_sel:[1,1,0] op_sel_hi:[0,1,1] neg_lo:[1,0,0]
    v_pk_mul_f32 v[2:3], v[36:37], v[0:1] op_sel_hi:[1,0]
    v_pk_fma_f32 v[42:43], v[36:37], v[0:1], v[2:3] op_sel:[1,1,0] op_sel_hi:[0,1,1] neg_lo:[1,0,0]
    v_pk_mul_f32 v[2:3], v[38:39], v[0:1] op_sel_hi:[1,0]
    v_pk_fma_f32 v[44:45], v[38:39], v[0:1], v[2:3] op_sel:[1,1,0] op_sel_hi:[0,1,1] neg_lo:[1,0,0]
    v_pk_mul_f32 v[2:3], v[40:41], v[0:1] op_sel_hi:[1,0]
    v_pk_fma_f32 v[46:47], v[40:41], v[0:1], v[2:3] op_sel:[1,1,0] op_sel_hi:[0,1,1] neg_lo:[1,0,0]
    v_pk_mul_f32 v[2:3], v[42:43], v[0:1] op_sel_hi:[1,0]
    v_pk_fma_f32 v[48:49], v[42:43], v[0:1], v[2:3] op_sel:[1,1,0] op_sel_hi:[0,1,1] neg_lo:[1,0,0]
    v_pk_mul_f32 v[2:3], v[46:47], v[0:1] op_sel_hi:[1,0]
    v_pk_fma_f32 v[50:51], v[46:47], v[0:1], v[2:3] op_sel:[1,1,0] op_sel_hi:[0,1,1] neg_lo:[1,0,0]
    v_pk_mul_f32 v[2:3], v[48:49], v[0:1] op_sel_hi:[1,0]
    v_pk_fma_f32 v[52:53], v[48:49], v[0:1], v[2:3] op_sel:[1,1,0] op_sel_hi:[0,1,1] neg_lo:[1,0,0]
    v_pk_mul_f32 v[2:3], v[50:51], v[0:1] op_sel_hi:[1,0]
    v_pk_fma_f32 v[54:55], v[50:51], v[0:1], v[2:3] op_sel:[1,1,0] op_sel_hi:[0,1,1] neg_lo:[1,0,0]
    v_pk_mul_f32 v[2:3], v[52:53], v[0:1] op_sel_hi:[1,0]
    s_add_u32 s74, s16, 14336
    buffer_load_dwordx4 v[246:249], v227, s[36:39], s74 offen
    v_pk_fma_f32 v[56:57], v[52:53], v[0:1], v[2:3] op_sel:[1,1,0] op_sel_hi:[0,1,1] neg_lo:[1,0,0]
    v_pk_mul_f32 v[2:3], v[54:55], v[0:1] op_sel_hi:[1,0]
    v_pk_fma_f32 v[58:59], v[54:55], v[0:1], v[2:3] op_sel:[1,1,0] op_sel_hi:[0,1,1] neg_lo:[1,0,0]
    v_pk_mul_f32 v[2:3], v[56:57], v[0:1] op_sel_hi:[1,0]
    v_pk_fma_f32 v[60:61], v[56:57], v[0:1], v[2:3] op_sel:[1,1,0] op_sel_hi:[0,1,1] neg_lo:[1,0,0]
    v_pk_mul_f32 v[2:3], v[58:59], v[0:1] op_sel_hi:[1,0]
    v_pk_fma_f32 v[62:63], v[58:59], v[0:1], v[2:3] op_sel:[1,1,0] op_sel_hi:[0,1,1] neg_lo:[1,0,0]
    v_cvt_pk_bf16_f32 v96, v8, v10
    v_cvt_pk_bf16_f32 v112, -v9, -v11
    v_cvt_pk_bf16_f32 v97, v12, v14
    v_cvt_pk_bf16_f32 v113, -v13, -v15
    v_cvt_pk_bf16_f32 v98, v26, v26
    v_cvt_pk_bf16_f32 v114, -v27, -v27
    v_cvt_pk_bf16_f32 v99, v28, v30
    v_cvt_pk_bf16_f32 v115, -v29, -v31
    v_cvt_pk_bf16_f32 v100, v16, v18
    v_cvt_pk_bf16_f32 v116, -v17, -v19
    v_cvt_pk_bf16_f32 v101, v20, v22
    v_cvt_pk_bf16_f32 v117, -v21, -v23
    v_cvt_pk_bf16_f32 v102, v30, v30
    v_cvt_pk_bf16_f32 v118, -v31, -v31
    v_cvt_pk_bf16_f32 v103, v32, v34
    v_cvt_pk_bf16_f32 v119, -v33, -v35
    v_cvt_pk_bf16_f32 v104, v36, v38
    v_cvt_pk_bf16_f32 v120, -v37, -v39
    v_cvt_pk_bf16_f32 v105, v40, v48
    v_cvt_pk_bf16_f32 v121, -v41, -v49
    v_cvt_pk_bf16_f32 v106, v42, v44
    v_cvt_pk_bf16_f32 v122, -v43, -v45
    v_cvt_pk_bf16_f32 v107, v46, v56
    v_cvt_pk_bf16_f32 v123, -v47, -v57
    v_cvt_pk_bf16_f32 v108, v50, v52
    v_cvt_pk_bf16_f32 v124, -v51, -v53
    v_cvt_pk_bf16_f32 v109, v54, v54
    v_cvt_pk_bf16_f32 v125, -v55, -v55
    v_cvt_pk_bf16_f32 v110, v58, v60
    v_cvt_pk_bf16_f32 v126, -v59, -v61
    v_cvt_pk_bf16_f32 v111, v62, v62
    v_cvt_pk_bf16_f32 v127, -v63, -v63
    ds_write_b128 v190, v[64:67]
    v_cvt_pk_bf16_f32 v8, 1.0, v148
    v_cvt_pk_bf16_f32 v24, 0, v149
    v_pk_mul_f32 v[2:3], v[148:149], v[148:149] op_sel_hi:[1,0]
    v_pk_fma_f32 v[4:5], v[148:149], v[148:149], v[2:3] op_sel:[1,1,0] op_sel_hi:[0,1,1] neg_lo:[1,0,0]
    v_pk_mul_f32 v[2:3], v[4:5], v[148:149] op_sel_hi:[1,0]
    v_pk_fma_f32 v[6:7], v[4:5], v[148:149], v[2:3] op_sel:[1,1,0] op_sel_hi:[0,1,1] neg_lo:[1,0,0]
    v_cvt_pk_bf16_f32 v9, v4, v6
    v_cvt_pk_bf16_f32 v25, v5, v7
    ds_write_b128 v191, v[68:71]
    v_pk_mul_f32 v[2:3], v[6:7], v[148:149] op_sel_hi:[1,0]
    v_pk_fma_f32 v[4:5], v[6:7], v[148:149], v[2:3] op_sel:[1,1,0] op_sel_hi:[0,1,1] neg_lo:[1,0,0]
    v_pk_mul_f32 v[2:3], v[4:5], v[148:149] op_sel_hi:[1,0]
    v_pk_fma_f32 v[6:7], v[4:5], v[148:149], v[2:3] op_sel:[1,1,0] op_sel_hi:[0,1,1] neg_lo:[1,0,0]
    v_cvt_pk_bf16_f32 v10, v4, v6
    v_cvt_pk_bf16_f32 v26, v5, v7
    v_pk_mul_f32 v[2:3], v[6:7], v[148:149] op_sel_hi:[1,0]
    v_pk_fma_f32 v[4:5], v[6:7], v[148:149], v[2:3] op_sel:[1,1,0] op_sel_hi:[0,1,1] neg_lo:[1,0,0]
    ds_write_b128 v192, v[72:75]
    v_pk_mul_f32 v[2:3], v[4:5], v[148:149] op_sel_hi:[1,0]
    v_pk_fma_f32 v[6:7], v[4:5], v[148:149], v[2:3] op_sel:[1,1,0] op_sel_hi:[0,1,1] neg_lo:[1,0,0]
    v_cvt_pk_bf16_f32 v11, v4, v6
    v_cvt_pk_bf16_f32 v27, v5, v7
    v_pk_mul_f32 v[2:3], v[6:7], v[148:149] op_sel_hi:[1,0]
    v_pk_fma_f32 v[4:5], v[6:7], v[148:149], v[2:3] op_sel:[1,1,0] op_sel_hi:[0,1,1] neg_lo:[1,0,0]
    v_pk_mul_f32 v[2:3], v[4:5], v[148:149] op_sel_hi:[1,0]
    v_pk_fma_f32 v[6:7], v[4:5], v[148:149], v[2:3] op_sel:[1,1,0] op_sel_hi:[0,1,1] neg_lo:[1,0,0]
    v_cvt_pk_bf16_f32 v12, v4, v6
    ds_write_b128 v193, v[76:79]
    v_cvt_pk_bf16_f32 v28, v5, v7
    v_pk_mul_f32 v[2:3], v[6:7], v[148:149] op_sel_hi:[1,0]
    v_pk_fma_f32 v[4:5], v[6:7], v[148:149], v[2:3] op_sel:[1,1,0] op_sel_hi:[0,1,1] neg_lo:[1,0,0]
    ds_read_b64_tr_b16 a[160:161], v196 offset:0
    ds_read_b64_tr_b16 a[162:163], v197 offset:0
    ds_read_b64_tr_b16 a[164:165], v196 offset:1024
    ds_read_b64_tr_b16 a[166:167], v197 offset:1024
    ds_read_b64_tr_b16 a[168:169], v196 offset:2048
    ds_read_b64_tr_b16 a[170:171], v197 offset:2048
    ds_read_b64_tr_b16 a[172:173], v196 offset:3072
    ds_read_b64_tr_b16 a[174:175], v197 offset:3072
    v_pk_mul_f32 v[2:3], v[4:5], v[148:149] op_sel_hi:[1,0]
    v_pk_fma_f32 v[6:7], v[4:5], v[148:149], v[2:3] op_sel:[1,1,0] op_sel_hi:[0,1,1] neg_lo:[1,0,0]
    v_cvt_pk_bf16_f32 v13, v4, v6
    v_cvt_pk_bf16_f32 v29, v5, v7
    v_pk_mul_f32 v[2:3], v[6:7], v[148:149] op_sel_hi:[1,0]
    ds_write_b128 v190, v[80:83]
    v_pk_fma_f32 v[4:5], v[6:7], v[148:149], v[2:3] op_sel:[1,1,0] op_sel_hi:[0,1,1] neg_lo:[1,0,0]
    v_pk_mul_f32 v[2:3], v[4:5], v[148:149] op_sel_hi:[1,0]
    v_pk_fma_f32 v[6:7], v[4:5], v[148:149], v[2:3] op_sel:[1,1,0] op_sel_hi:[0,1,1] neg_lo:[1,0,0]
    v_cvt_pk_bf16_f32 v14, v4, v6
    v_cvt_pk_bf16_f32 v30, v5, v7
    v_pk_mul_f32 v[2:3], v[6:7], v[148:149] op_sel_hi:[1,0]
    v_pk_fma_f32 v[4:5], v[6:7], v[148:149], v[2:3] op_sel:[1,1,0] op_sel_hi:[0,1,1] neg_lo:[1,0,0]
    v_pk_mul_f32 v[2:3], v[4:5], v[148:149] op_sel_hi:[1,0]
    ds_write_b128 v191, v[84:87]
    v_pk_fma_f32 v[6:7], v[4:5], v[148:149], v[2:3] op_sel:[1,1,0] op_sel_hi:[0,1,1] neg_lo:[1,0,0]
    v_cvt_pk_bf16_f32 v15, v4, v6
    v_cvt_pk_bf16_f32 v31, v5, v7
    v_pk_mul_f32 v[2:3], v[6:7], v[148:149] op_sel_hi:[1,0]
    v_pk_fma_f32 v[4:5], v[6:7], v[148:149], v[2:3] op_sel:[1,1,0] op_sel_hi:[0,1,1] neg_lo:[1,0,0]
    v_pk_mul_f32 v[2:3], v[4:5], v[148:149] op_sel_hi:[1,0]
    v_pk_fma_f32 v[6:7], v[4:5], v[148:149], v[2:3] op_sel:[1,1,0] op_sel_hi:[0,1,1] neg_lo:[1,0,0]
    v_cvt_pk_bf16_f32 v16, v4, v6
    v_cvt_pk_bf16_f32 v32, v5, v7
    ds_write_b128 v192, v[88:91]
    v_pk_mul_f32 v[2:3], v[6:7], v[148:149] op_sel_hi:[1,0]
    v_pk_fma_f32 v[4:5], v[6:7], v[148:149], v[2:3] op_sel:[1,1,0] op_sel_hi:[0,1,1] neg_lo:[1,0,0]
    v_pk_mul_f32 v[2:3], v[4:5], v[148:149] op_sel_hi:[1,0]
    v_pk_fma_f32 v[6:7], v[4:5], v[148:149], v[2:3] op_sel:[1,1,0] op_sel_hi:[0,1,1] neg_lo:[1,0,0]
    v_cvt_pk_bf16_f32 v17, v4, v6
    v_cvt_pk_bf16_f32 v33, v5, v7
    v_pk_mul_f32 v[2:3], v[6:7], v[148:149] op_sel_hi:[1,0]
    v_pk_fma_f32 v[4:5], v[6:7], v[148:149], v[2:3] op_sel:[1,1,0] op_sel_hi:[0,1,1] neg_lo:[1,0,0]
    ds_write_b128 v193, v[92:95]
    v_pk_mul_f32 v[2:3], v[4:5], v[148:149] op_sel_hi:[1,0]
    v_pk_fma_f32 v[6:7], v[4:5], v[148:149], v[2:3] op_sel:[1,1,0] op_sel_hi:[0,1,1] neg_lo:[1,0,0]
    v_cvt_pk_bf16_f32 v18, v4, v6
    ds_read_b64_tr_b16 a[176:177], v196 offset:0
    ds_read_b64_tr_b16 a[178:179], v197 offset:0
    ds_read_b64_tr_b16 a[180:181], v196 offset:1024
    ds_read_b64_tr_b16 a[182:183], v197 offset:1024
    ds_read_b64_tr_b16 a[184:185], v196 offset:2048
    ds_read_b64_tr_b16 a[186:187], v197 offset:2048
    ds_read_b64_tr_b16 a[188:189], v196 offset:3072
    ds_read_b64_tr_b16 a[190:191], v197 offset:3072
    v_cvt_pk_bf16_f32 v34, v5, v7
    v_pk_mul_f32 v[2:3], v[6:7], v[148:149] op_sel_hi:[1,0]
    v_pk_fma_f32 v[4:5], v[6:7], v[148:149], v[2:3] op_sel:[1,1,0] op_sel_hi:[0,1,1] neg_lo:[1,0,0]
    v_pk_mul_f32 v[2:3], v[4:5], v[148:149] op_sel_hi:[1,0]
    v_pk_fma_f32 v[6:7], v[4:5], v[148:149], v[2:3] op_sel:[1,1,0] op_sel_hi:[0,1,1] neg_lo:[1,0,0]
    ds_write_b128 v190, v[8:11]
    v_cvt_pk_bf16_f32 v19, v4, v6
    v_cvt_pk_bf16_f32 v35, v5, v7
    v_pk_mul_f32 v[2:3], v[6:7], v[148:149] op_sel_hi:[1,0]
    v_pk_fma_f32 v[4:5], v[6:7], v[148:149], v[2:3] op_sel:[1,1,0] op_sel_hi:[0,1,1] neg_lo:[1,0,0]
    v_pk_mul_f32 v[2:3], v[4:5], v[148:149] op_sel_hi:[1,0]
    v_pk_fma_f32 v[6:7], v[4:5], v[148:149], v[2:3] op_sel:[1,1,0] op_sel_hi:[0,1,1] neg_lo:[1,0,0]
    v_cvt_pk_bf16_f32 v20, v4, v6
    v_cvt_pk_bf16_f32 v36, v5, v7
    v_pk_mul_f32 v[2:3], v[6:7], v[148:149] op_sel_hi:[1,0]
    ds_write_b128 v191, v[12:15]
    v_pk_fma_f32 v[4:5], v[6:7], v[148:149], v[2:3] op_sel:[1,1,0] op_sel_hi:[0,1,1] neg_lo:[1,0,0]
    v_pk_mul_f32 v[2:3], v[4:5], v[148:149] op_sel_hi:[1,0]
    v_pk_fma_f32 v[6:7], v[4:5], v[148:149], v[2:3] op_sel:[1,1,0] op_sel_hi:[0,1,1] neg_lo:[1,0,0]
    v_cvt_pk_bf16_f32 v21, v4, v6
    v_cvt_pk_bf16_f32 v37, v5, v7
    v_pk_mul_f32 v[2:3], v[6:7], v[148:149] op_sel_hi:[1,0]
    v_pk_fma_f32 v[4:5], v[6:7], v[148:149], v[2:3] op_sel:[1,1,0] op_sel_hi:[0,1,1] neg_lo:[1,0,0]
    v_pk_mul_f32 v[2:3], v[4:5], v[148:149] op_sel_hi:[1,0]
    ds_write_b128 v192, v[16:19]
    v_pk_fma_f32 v[6:7], v[4:5], v[148:149], v[2:3] op_sel:[1,1,0] op_sel_hi:[0,1,1] neg_lo:[1,0,0]
    v_cvt_pk_bf16_f32 v22, v4, v6
    v_cvt_pk_bf16_f32 v38, v5, v7
    v_pk_mul_f32 v[2:3], v[6:7], v[148:149] op_sel_hi:[1,0]
    v_pk_fma_f32 v[4:5], v[6:7], v[148:149], v[2:3] op_sel:[1,1,0] op_sel_hi:[0,1,1] neg_lo:[1,0,0]
    v_pk_mul_f32 v[2:3], v[4:5], v[148:149] op_sel_hi:[1,0]
    v_pk_fma_f32 v[6:7], v[4:5], v[148:149], v[2:3] op_sel:[1,1,0] op_sel_hi:[0,1,1] neg_lo:[1,0,0]
    v_cvt_pk_bf16_f32 v23, v4, v6
    v_cvt_pk_bf16_f32 v39, v5, v7
    ds_write_b128 v193, v[20:23]
    ds_read_b64_tr_b16 a[192:193], v194 offset:0
    ds_read_b64_tr_b16 a[194:195], v195 offset:0
    ds_read_b64_tr_b16 a[196:197], v194 offset:1024
    ds_read_b64_tr_b16 a[198:199], v195 offset:1024
    ds_read_b64_tr_b16 a[200:201], v194 offset:2048
    ds_read_b64_tr_b16 a[202:203], v195 offset:2048
    ds_read_b64_tr_b16 a[204:205], v194 offset:3072
    ds_read_b64_tr_b16 a[206:207], v195 offset:3072
    v_cvt_pk_bf16_f32 v64, 1.0, v150
    v_cvt_pk_bf16_f32 v80, 0, v151
    ds_write_b128 v190, v[24:27]
    v_pk_mul_f32 v[2:3], v[150:151], v[150:151] op_sel_hi:[1,0]
    v_pk_fma_f32 v[4:5], v[150:151], v[150:151], v[2:3] op_sel:[1,1,0] op_sel_hi:[0,1,1] neg_lo:[1,0,0]
    v_pk_mul_f32 v[2:3], v[4:5], v[150:151] op_sel_hi:[1,0]
    v_pk_fma_f32 v[6:7], v[4:5], v[150:151], v[2:3] op_sel:[1,1,0] op_sel_hi:[0,1,1] neg_lo:[1,0,0]
    v_cvt_pk_bf16_f32 v65, v4, v6
    v_cvt_pk_bf16_f32 v81, v5, v7
    ds_write_b128 v191, v[28:31]
    v_pk_mul_f32 v[2:3], v[6:7], v[150:151] op_sel_hi:[1,0]
    v_pk_fma_f32 v[4:5], v[6:7], v[150:151], v[2:3] op_sel:[1,1,0] op_sel_hi:[0,1,1] neg_lo:[1,0,0]
    v_pk_mul_f32 v[2:3], v[4:5], v[150:151] op_sel_hi:[1,0]
    v_pk_fma_f32 v[6:7], v[4:5], v[150:151], v[2:3] op_sel:[1,1,0] op_sel_hi:[0,1,1] neg_lo:[1,0,0]
    v_cvt_pk_bf16_f32 v66, v4, v6
    v_cvt_pk_bf16_f32 v82, v5, v7
    ds_write_b128 v192, v[32:35]
    v_pk_mul_f32 v[2:3], v[6:7], v[150:151] op_sel_hi:[1,0]
    v_pk_fma_f32 v[4:5], v[6:7], v[150:151], v[2:3] op_sel:[1,1,0] op_sel_hi:[0,1,1] neg_lo:[1,0,0]
    v_pk_mul_f32 v[2:3], v[4:5], v[150:151] op_sel_hi:[1,0]
    v_pk_fma_f32 v[6:7], v[4:5], v[150:151], v[2:3] op_sel:[1,1,0] op_sel_hi:[0,1,1] neg_lo:[1,0,0]
    v_cvt_pk_bf16_f32 v67, v4, v6
    v_cvt_pk_bf16_f32 v83, v5, v7
    ds_write_b128 v193, v[36:39]
    v_pk_mul_f32 v[2:3], v[6:7], v[150:151] op_sel_hi:[1,0]
    v_pk_fma_f32 v[4:5], v[6:7], v[150:151], v[2:3] op_sel:[1,1,0] op_sel_hi:[0,1,1] neg_lo:[1,0,0]
    v_pk_mul_f32 v[2:3], v[4:5], v[150:151] op_sel_hi:[1,0]
    ds_read_b64_tr_b16 a[208:209], v194 offset:0
    ds_read_b64_tr_b16 a[210:211], v195 offset:0
    ds_read_b64_tr_b16 a[212:213], v194 offset:1024
    ds_read_b64_tr_b16 a[214:215], v195 offset:1024
    ds_read_b64_tr_b16 a[216:217], v194 offset:2048
    ds_read_b64_tr_b16 a[218:219], v195 offset:2048
    ds_read_b64_tr_b16 a[220:221], v194 offset:3072
    ds_read_b64_tr_b16 a[222:223], v195 offset:3072
    v_pk_fma_f32 v[6:7], v[4:5], v[150:151], v[2:3] op_sel:[1,1,0] op_sel_hi:[0,1,1] neg_lo:[1,0,0]
    v_cvt_pk_bf16_f32 v68, v4, v6
    v_cvt_pk_bf16_f32 v84, v5, v7
    ds_write_b128 v190, v[96:99]
    v_pk_mul_f32 v[2:3], v[6:7], v[150:151] op_sel_hi:[1,0]
    v_pk_fma_f32 v[4:5], v[6:7], v[150:151], v[2:3] op_sel:[1,1,0] op_sel_hi:[0,1,1] neg_lo:[1,0,0]
    v_pk_mul_f32 v[2:3], v[4:5], v[150:151] op_sel_hi:[1,0]
    v_pk_fma_f32 v[6:7], v[4:5], v[150:151], v[2:3] op_sel:[1,1,0] op_sel_hi:[0,1,1] neg_lo:[1,0,0]
    v_cvt_pk_bf16_f32 v69, v4, v6
    v_cvt_pk_bf16_f32 v85, v5, v7
    ds_write_b128 v191, v[100:103]
    v_pk_mul_f32 v[2:3], v[6:7], v[150:151] op_sel_hi:[1,0]
    v_pk_fma_f32 v[4:5], v[6:7], v[150:151], v[2:3] op_sel:[1,1,0] op_sel_hi:[0,1,1] neg_lo:[1,0,0]
    v_pk_mul_f32 v[2:3], v[4:5], v[150:151] op_sel_hi:[1,0]
    v_pk_fma_f32 v[6:7], v[4:5], v[150:151], v[2:3] op_sel:[1,1,0] op_sel_hi:[0,1,1] neg_lo:[1,0,0]
    v_cvt_pk_bf16_f32 v70, v4, v6
    v_cvt_pk_bf16_f32 v86, v5, v7
    ds_write_b128 v192, v[104:107]
    v_pk_mul_f32 v[2:3], v[6:7], v[150:151] op_sel_hi:[1,0]
    v_pk_fma_f32 v[4:5], v[6:7], v[150:151], v[2:3] op_sel:[1,1,0] op_sel_hi:[0,1,1] neg_lo:[1,0,0]
    v_pk_mul_f32 v[2:3], v[4:5], v[150:151] op_sel_hi:[1,0]
    v_pk_fma_f32 v[6:7], v[4:5], v[150:151], v[2:3] op_sel:[1,1,0] op_sel_hi:[0,1,1] neg_lo:[1,0,0]
    v_cvt_pk_bf16_f32 v71, v4, v6
    v_cvt_pk_bf16_f32 v87, v5, v7
    ds_write_b128 v193, v[108:111]
    v_pk_mul_f32 v[2:3], v[6:7], v[150:151] op_sel_hi:[1,0]
    v_pk_fma_f32 v[4:5], v[6:7], v[150:151], v[2:3] op_sel:[1,1,0] op_sel_hi:[0,1,1] neg_lo:[1,0,0]
    v_pk_mul_f32 v[2:3], v[4:5], v[150:151] op_sel_hi:[1,0]
    ds_read_b64_tr_b16 a[96:97], v196 offset:0
    ds_read_b64_tr_b16 a[98:99], v197 offset:0
    ds_read_b64_tr_b16 a[100:101], v196 offset:1024
    ds_read_b64_tr_b16 a[102:103], v197 offset:1024
    ds_read_b64_tr_b16 a[104:105], v196 offset:2048
    ds_read_b64_tr_b16 a[106:107], v197 offset:2048
    ds_read_b64_tr_b16 a[108:109], v196 offset:3072
    ds_read_b64_tr_b16 a[110:111], v197 offset:3072
    v_pk_fma_f32 v[6:7], v[4:5], v[150:151], v[2:3] op_sel:[1,1,0] op_sel_hi:[0,1,1] neg_lo:[1,0,0]
    v_cvt_pk_bf16_f32 v72, v4, v6
    v_cvt_pk_bf16_f32 v88, v5, v7
    ds_write_b128 v190, v[112:115]
    v_pk_mul_f32 v[2:3], v[6:7], v[150:151] op_sel_hi:[1,0]
    v_pk_fma_f32 v[4:5], v[6:7], v[150:151], v[2:3] op_sel:[1,1,0] op_sel_hi:[0,1,1] neg_lo:[1,0,0]
    v_pk_mul_f32 v[2:3], v[4:5], v[150:151] op_sel_hi:[1,0]
    v_pk_fma_f32 v[6:7], v[4:5], v[150:151], v[2:3] op_sel:[1,1,0] op_sel_hi:[0,1,1] neg_lo:[1,0,0]
    v_cvt_pk_bf16_f32 v73, v4, v6
    v_cvt_pk_bf16_f32 v89, v5, v7
    ds_write_b128 v191, v[116:119]
    v_pk_mul_f32 v[2:3], v[6:7], v[150:151] op_sel_hi:[1,0]
    v_pk_fma_f32 v[4:5], v[6:7], v[150:151], v[2:3] op_sel:[1,1,0] op_sel_hi:[0,1,1] neg_lo:[1,0,0]
    v_pk_mul_f32 v[2:3], v[4:5], v[150:151] op_sel_hi:[1,0]
    v_pk_fma_f32 v[6:7], v[4:5], v[150:151], v[2:3] op_sel:[1,1,0] op_sel_hi:[0,1,1] neg_lo:[1,0,0]
    v_cvt_pk_bf16_f32 v74, v4, v6
    v_cvt_pk_bf16_f32 v90, v5, v7
    ds_write_b128 v192, v[120:123]
    v_pk_mul_f32 v[2:3], v[6:7], v[150:151] op_sel_hi:[1,0]
    v_pk_fma_f32 v[4:5], v[6:7], v[150:151], v[2:3] op_sel:[1,1,0] op_sel_hi:[0,1,1] neg_lo:[1,0,0]
    v_pk_mul_f32 v[2:3], v[4:5], v[150:151] op_sel_hi:[1,0]
    v_pk_fma_f32 v[6:7], v[4:5], v[150:151], v[2:3] op_sel:[1,1,0] op_sel_hi:[0,1,1] neg_lo:[1,0,0]
    v_cvt_pk_bf16_f32 v75, v4, v6
    v_cvt_pk_bf16_f32 v91, v5, v7
    ds_write_b128 v193, v[124:127]
    v_pk_mul_f32 v[2:3], v[6:7], v[150:151] op_sel_hi:[1,0]
    v_pk_fma_f32 v[4:5], v[6:7], v[150:151], v[2:3] op_sel:[1,1,0] op_sel_hi:[0,1,1] neg_lo:[1,0,0]
    v_pk_mul_f32 v[2:3], v[4:5], v[150:151] op_sel_hi:[1,0]
    ds_read_b64_tr_b16 a[112:113], v196 offset:0
    ds_read_b64_tr_b16 a[114:115], v197 offset:0
    ds_read_b64_tr_b16 a[116:117], v196 offset:1024
    ds_read_b64_tr_b16 a[118:119], v197 offset:1024
    ds_read_b64_tr_b16 a[120:121], v196 offset:2048
    ds_read_b64_tr_b16 a[122:123], v197 offset:2048
    ds_read_b64_tr_b16 a[124:125], v196 offset:3072
    ds_read_b64_tr_b16 a[126:127], v197 offset:3072
    v_pk_fma_f32 v[6:7], v[4:5], v[150:151], v[2:3] op_sel:[1,1,0] op_sel_hi:[0,1,1] neg_lo:[1,0,0]
    v_cvt_pk_bf16_f32 v76, v4, v6
    v_cvt_pk_bf16_f32 v92, v5, v7
    ds_write_b128 v190, v[64:67]
    v_pk_mul_f32 v[2:3], v[6:7], v[150:151] op_sel_hi:[1,0]
    v_pk_fma_f32 v[4:5], v[6:7], v[150:151], v[2:3] op_sel:[1,1,0] op_sel_hi:[0,1,1] neg_lo:[1,0,0]
    v_pk_mul_f32 v[2:3], v[4:5], v[150:151] op_sel_hi:[1,0]
    v_pk_fma_f32 v[6:7], v[4:5], v[150:151], v[2:3] op_sel:[1,1,0] op_sel_hi:[0,1,1] neg_lo:[1,0,0]
    v_cvt_pk_bf16_f32 v77, v4, v6
    v_cvt_pk_bf16_f32 v93, v5, v7
    ds_write_b128 v191, v[68:71]
    v_pk_mul_f32 v[2:3], v[6:7], v[150:151] op_sel_hi:[1,0]
    v_pk_fma_f32 v[4:5], v[6:7], v[150:151], v[2:3] op_sel:[1,1,0] op_sel_hi:[0,1,1] neg_lo:[1,0,0]
    v_pk_mul_f32 v[2:3], v[4:5], v[150:151] op_sel_hi:[1,0]
    v_pk_fma_f32 v[6:7], v[4:5], v[150:151], v[2:3] op_sel:[1,1,0] op_sel_hi:[0,1,1] neg_lo:[1,0,0]
    v_cvt_pk_bf16_f32 v78, v4, v6
    v_cvt_pk_bf16_f32 v94, v5, v7
    ds_write_b128 v192, v[72:75]
    v_pk_mul_f32 v[2:3], v[6:7], v[150:151] op_sel_hi:[1,0]
    v_pk_fma_f32 v[4:5], v[6:7], v[150:151], v[2:3] op_sel:[1,1,0] op_sel_hi:[0,1,1] neg_lo:[1,0,0]
    v_pk_mul_f32 v[2:3], v[4:5], v[150:151] op_sel_hi:[1,0]
    v_pk_fma_f32 v[6:7], v[4:5], v[150:151], v[2:3] op_sel:[1,1,0] op_sel_hi:[0,1,1] neg_lo:[1,0,0]
    v_cvt_pk_bf16_f32 v79, v4, v6
    v_cvt_pk_bf16_f32 v95, v5, v7
    ds_write_b128 v193, v[76:79]
    s_waitcnt lgkmcnt(15)
    v_mfma_f32_32x32x16_bf16 a[240:255], a[160:163], a[192:195], 0
    ds_read_b64_tr_b16 a[128:129], v194 offset:0
    ds_read_b64_tr_b16 a[130:131], v195 offset:0
    ds_read_b64_tr_b16 a[132:133], v194 offset:1024
    ds_read_b64_tr_b16 a[134:135], v195 offset:1024
    ds_read_b64_tr_b16 a[136:137], v194 offset:2048
    ds_read_b64_tr_b16 a[138:139], v195 offset:2048
    ds_read_b64_tr_b16 a[140:141], v194 offset:3072
    ds_read_b64_tr_b16 a[142:143], v195 offset:3072
    v_mfma_f32_32x32x16_bf16 a[240:255], a[164:167], a[196:199], a[240:255]
    ds_write_b128 v190, v[80:83]
    v_mfma_f32_32x32x16_bf16 a[240:255], a[168:171], a[200:203], a[240:255]
    v_lshlrev_b32_e64 v135, 16, v135
    v_mfma_f32_32x32x16_bf16 a[240:255], a[172:175], a[204:207], a[240:255]
    ds_write_b128 v191, v[84:87]
    v_mfma_f32_32x32x16_bf16 a[240:255], a[176:179], a[208:211], a[240:255]
    ds_write_b128 v192, v[88:91]
    v_mfma_f32_32x32x16_bf16 a[240:255], a[180:183], a[212:215], a[240:255]
    ds_write_b128 v193, v[92:95]
    v_mfma_f32_32x32x16_bf16 a[240:255], a[184:187], a[216:219], a[240:255]
    ds_read_b64_tr_b16 a[144:145], v194 offset:0
    ds_read_b64_tr_b16 a[146:147], v195 offset:0
    ds_read_b64_tr_b16 a[148:149], v194 offset:1024
    ds_read_b64_tr_b16 a[150:151], v195 offset:1024
    ds_read_b64_tr_b16 a[152:153], v194 offset:2048
    ds_read_b64_tr_b16 a[154:155], v195 offset:2048
    ds_read_b64_tr_b16 a[156:157], v194 offset:3072
    ds_read_b64_tr_b16 a[158:159], v195 offset:3072
    s_waitcnt vmcnt(7)
    v_mfma_f32_32x32x16_bf16 a[240:255], a[188:191], a[220:223], a[240:255]
    s_waitcnt lgkmcnt(0)
    s_barrier
    v_mfma_f32_32x32x16_bf16 a[240:255], a[96:99], a[128:131], a[240:255]
    ds_read_b128 a[0:3], v172 offset:0
    ds_read_b128 a[4:7], v172 offset:4096
    ds_read_b128 a[8:11], v173 offset:0
    v_mfma_f32_32x32x16_bf16 a[240:255], a[100:103], a[132:135], a[240:255]
    ds_read_b128 a[12:15], v173 offset:4096
    ds_read_b128 a[16:19], v174 offset:0
    ds_read_b128 a[20:23], v174 offset:4096
    v_mfma_f32_32x32x16_bf16 a[240:255], a[104:107], a[136:139], a[240:255]
    ds_read_b128 a[24:27], v175 offset:0
    ds_read_b128 a[28:31], v175 offset:4096
    ds_read_b128 a[32:35], v172 offset:16384
    v_mfma_f32_32x32x16_bf16 a[240:255], a[108:111], a[140:143], a[240:255]
    ds_read_b128 a[36:39], v172 offset:20480
    ds_read_b128 a[40:43], v173 offset:16384
    ds_read_b128 a[44:47], v173 offset:20480
    v_mfma_f32_32x32x16_bf16 a[240:255], a[112:115], a[144:147], a[240:255]
    ds_read_b128 a[48:51], v174 offset:16384
    ds_read_b128 a[52:55], v174 offset:20480
    ds_read_b128 a[56:59], v175 offset:16384
    v_mfma_f32_32x32x16_bf16 a[240:255], a[116:119], a[148:151], a[240:255]
    ds_read_b128 a[60:63], v175 offset:20480
    ds_read_b64_tr_b16 a[224:225], v188 offset:0
    ds_read_b64_tr_b16 a[226:227], v188 offset:1024
    v_mfma_f32_32x32x16_bf16 a[240:255], a[120:123], a[152:155], a[240:255]
    ds_read_b64_tr_b16 a[228:229], v189 offset:0
    ds_read_b64_tr_b16 a[230:231], v189 offset:1024
    ds_read_b64_tr_b16 a[232:233], v188 offset:256
    v_mfma_f32_32x32x16_bf16 a[240:255], a[124:127], a[156:159], a[240:255]
    ds_read_b64_tr_b16 a[234:235], v188 offset:1280
    ds_read_b64_tr_b16 a[236:237], v189 offset:256
    ds_read_b64_tr_b16 a[238:239], v189 offset:1280
    v_readfirstlane_b32 s67, v135
    s_waitcnt lgkmcnt(8)
    s_barrier
    s_nop 5
    ds_write_b128 v170, a[248:251]
    ds_write_b128 v170, a[252:255] offset:1024
    ds_write_b128 v170, a[244:247] offset:2048
    s_add_u32 m0, s77, 32768
    s_waitcnt lgkmcnt(9)
    v_mfma_f32_32x32x16_bf16 v[0:15], a[224:227], a[0:3], 0
    buffer_load_dwordx4 v184, s[40:43], s65 offen  lds
    v_mfma_f32_32x32x16_bf16 v[64:79], a[224:227], a[4:7], 0
    ds_read_b64_tr_b16 a[224:225], v188 offset:4096
    ds_read_b64_tr_b16 a[226:227], v188 offset:5120
    s_lshl_b32 s66, s63, 7
    s_mov_b32 s44, s28
    s_mov_b32 s45, s29
    s_waitcnt lgkmcnt(9)
    v_mfma_f32_32x32x16_bf16 v[16:31], a[228:231], a[0:3], 0
    buffer_load_dwordx4 v185, s[40:43], s65 offen offset:1024  lds
    v_mfma_f32_32x32x16_bf16 v[80:95], a[228:231], a[4:7], 0
    ds_read_b64_tr_b16 a[228:229], v189 offset:4096
    ds_read_b64_tr_b16 a[230:231], v189 offset:5120
    s_mov_b32 s46, 1605632
    s_mov_b32 s47, 0x20000
    s_add_u32 s48, s34, 0
    s_addc_u32 s49, s35, 0
    s_waitcnt lgkmcnt(9)
    v_mfma_f32_32x32x16_bf16 v[32:47], a[232:235], a[0:3], 0
    buffer_load_dwordx4 v186, s[40:43], s65 offen offset:2048  lds
    v_mfma_f32_32x32x16_bf16 v[96:111], a[232:235], a[4:7], 0
    ds_read_b64_tr_b16 a[232:233], v188 offset:4352
    ds_read_b64_tr_b16 a[234:235], v188 offset:5376
    s_mov_b32 s52, s30
    s_mov_b32 s53, s31
    s_mov_b32 s54, 1835008
    s_waitcnt lgkmcnt(9)
    v_mfma_f32_32x32x16_bf16 v[48:63], a[236:239], a[0:3], 0
    buffer_load_dwordx4 v187, s[40:43], s65 offen offset:3072  lds
    s_add_u32 s65, s65, 114688
    v_mfma_f32_32x32x16_bf16 v[112:127], a[236:239], a[4:7], 0
    ds_read_b64_tr_b16 a[236:237], v189 offset:4352
    ds_read_b64_tr_b16 a[238:239], v189 offset:5376
    s_mov_b32 s55, 0x20000
    s_mul_i32 s80, s57, 1024
    s_add_u32 s80, s80, 11698176
    s_waitcnt vmcnt(7) lgkmcnt(8)
    s_barrier
    s_add_u32 m0, s77, 49152
    s_waitcnt lgkmcnt(4)
    v_mfma_f32_32x32x16_bf16 v[0:15], a[224:227], a[8:11], v[0:15]
    buffer_load_dwordx4 v184, s[40:43], s65 offen  lds
    v_mfma_f32_32x32x16_bf16 v[64:79], a[224:227], a[12:15], v[64:79]
    ds_read_b64_tr_b16 a[224:225], v188 offset:16384
    ds_read_b64_tr_b16 a[226:227], v188 offset:17408
    s_and_b32 s81, s81, 254
    s_lshl_b32 s90, s81, 8
    v_mfma_f32_32x32x16_bf16 v[16:31], a[228:231], a[8:11], v[16:31]
    buffer_load_dwordx4 v185, s[40:43], s65 offen offset:1024  lds
    v_mfma_f32_32x32x16_bf16 v[80:95], a[228:231], a[12:15], v[80:95]
    ds_read_b64_tr_b16 a[228:229], v189 offset:16384
    ds_read_b64_tr_b16 a[230:231], v189 offset:17408
    s_waitcnt lgkmcnt(4)
    s_add_u32 s90, s90, 11534336
    v_mfma_f32_32x32x16_bf16 v[32:47], a[232:235], a[8:11], v[32:47]
    buffer_load_dwordx4 v186, s[40:43], s65 offen offset:2048  lds
    v_mfma_f32_32x32x16_bf16 v[96:111], a[232:235], a[12:15], v[96:111]
    ds_read_b64_tr_b16 a[232:233], v188 offset:16640
    ds_read_b64_tr_b16 a[234:235], v188 offset:17664
    s_lshl_b32 s18, s60, 1
    s_add_u32 s18, s18, s85
    v_mfma_f32_32x32x16_bf16 v[48:63], a[236:239], a[8:11], v[48:63]
    buffer_load_dwordx4 v187, s[40:43], s65 offen offset:3072  lds
    s_add_u32 s65, s65, 114688
    v_mfma_f32_32x32x16_bf16 v[112:127], a[236:239], a[12:15], v[112:127]
    ds_read_b64_tr_b16 a[236:237], v189 offset:16640
    ds_read_b64_tr_b16 a[238:239], v189 offset:17664
    s_lshl_b32 s91, s18, 9
    s_add_u32 s91, s91, 11550720
    s_add_u32 m0, s73, 65536
    s_waitcnt lgkmcnt(4)
    v_mfma_f32_32x32x16_bf16 v[0:15], a[224:227], a[16:19], v[0:15]
    buffer_load_dwordx4 v180, s[36:39], s72 offen  lds
    v_mfma_f32_32x32x16_bf16 v[64:79], a[224:227], a[20:23], v[64:79]
    ds_read_b64_tr_b16 a[224:225], v188 offset:20480
    ds_read_b64_tr_b16 a[226:227], v188 offset:21504
    v_mfma_f32_32x32x16_bf16 v[16:31], a[228:231], a[16:19], v[16:31]
    buffer_load_dwordx4 v181, s[36:39], s72 offen offset:1024  lds
    v_mfma_f32_32x32x16_bf16 v[80:95], a[228:231], a[20:23], v[80:95]
    ds_read_b64_tr_b16 a[228:229], v189 offset:20480
    ds_read_b64_tr_b16 a[230:231], v189 offset:21504
    s_waitcnt lgkmcnt(4)
    v_mfma_f32_32x32x16_bf16 v[32:47], a[232:235], a[16:19], v[32:47]
    buffer_load_dwordx4 v182, s[36:39], s72 offen offset:2048  lds
    v_mfma_f32_32x32x16_bf16 v[96:111], a[232:235], a[20:23], v[96:111]
    ds_read_b64_tr_b16 a[232:233], v188 offset:20736
    ds_read_b64_tr_b16 a[234:235], v188 offset:21760
    v_mfma_f32_32x32x16_bf16 v[48:63], a[236:239], a[16:19], v[48:63]
    buffer_load_dwordx4 v183, s[36:39], s72 offen offset:3072  lds
    s_add_u32 s72, s72, 128
    v_mfma_f32_32x32x16_bf16 v[112:127], a[236:239], a[20:23], v[112:127]
    ds_read_b64_tr_b16 a[236:237], v189 offset:20736
    ds_read_b64_tr_b16 a[238:239], v189 offset:21760
    s_waitcnt vmcnt(8)
    s_barrier
    s_add_u32 m0, s77, 0
    s_waitcnt lgkmcnt(4)
    v_mfma_f32_32x32x16_bf16 v[0:15], a[224:227], a[24:27], v[0:15]
    buffer_load_dwordx4 v184, s[40:43], s65 offen  lds
    v_mfma_f32_32x32x16_bf16 v[64:79], a[224:227], a[28:31], v[64:79]
    ds_read_b64_tr_b16 a[224:225], v188 offset:32768
    ds_read_b64_tr_b16 a[226:227], v188 offset:33792
    v_accvgpr_read_b32 v128, a240
    v_accvgpr_read_b32 v129, a241
    v_mfma_f32_32x32x16_bf16 v[16:31], a[228:231], a[24:27], v[16:31]
    buffer_load_dwordx4 v185, s[40:43], s65 offen offset:1024  lds
    v_mfma_f32_32x32x16_bf16 v[80:95], a[228:231], a[28:31], v[80:95]
    ds_read_b64_tr_b16 a[228:229], v189 offset:32768
    ds_read_b64_tr_b16 a[230:231], v189 offset:33792
    s_waitcnt lgkmcnt(4)
    v_accvgpr_read_b32 v130, a242
    v_mfma_f32_32x32x16_bf16 v[32:47], a[232:235], a[24:27], v[32:47]
    buffer_load_dwordx4 v186, s[40:43], s65 offen offset:2048  lds
    v_mfma_f32_32x32x16_bf16 v[96:111], a[232:235], a[28:31], v[96:111]
    ds_read_b64_tr_b16 a[232:233], v188 offset:33024
    ds_read_b64_tr_b16 a[234:235], v188 offset:34048
    v_accvgpr_read_b32 v131, a243
    v_accvgpr_read_b32 v132, a244
    v_mfma_f32_32x32x16_bf16 v[48:63], a[236:239], a[24:27], v[48:63]
    buffer_load_dwordx4 v187, s[40:43], s65 offen offset:3072  lds
    s_add_u32 s65, s65, 114688
    v_mfma_f32_32x32x16_bf16 v[112:127], a[236:239], a[28:31], v[112:127]
    ds_read_b64_tr_b16 a[236:237], v189 offset:33024
    ds_read_b64_tr_b16 a[238:239], v189 offset:34048
    v_accvgpr_read_b32 v133, a245
    v_accvgpr_read_b32 v134, a246
    v_accvgpr_read_b32 v135, a247
    s_add_u32 m0, s73, 81920
    s_waitcnt lgkmcnt(4)
    v_mfma_f32_32x32x16_bf16 v[0:15], a[224:227], a[32:35], v[0:15]
    buffer_load_dwordx4 v180, s[36:39], s72 offen  lds
    v_mfma_f32_32x32x16_bf16 v[64:79], a[224:227], a[36:39], v[64:79]
    ds_read_b64_tr_b16 a[224:225], v188 offset:36864
    ds_read_b64_tr_b16 a[226:227], v188 offset:37888
    ds_read_b128 v[136:139], v171
    v_mfma_f32_32x32x16_bf16 v[16:31], a[228:231], a[32:35], v[16:31]
    buffer_load_dwordx4 v181, s[36:39], s72 offen offset:1024  lds
    v_mfma_f32_32x32x16_bf16 v[80:95], a[228:231], a[36:39], v[80:95]
    ds_read_b64_tr_b16 a[228:229], v189 offset:36864
    ds_read_b64_tr_b16 a[230:231], v189 offset:37888
    s_waitcnt lgkmcnt(5)
    v_mfma_f32_32x32x16_bf16 v[32:47], a[232:235], a[32:35], v[32:47]
    buffer_load_dwordx4 v182, s[36:39], s72 offen offset:2048  lds
    v_mfma_f32_32x32x16_bf16 v[96:111], a[232:235], a[36:39], v[96:111]
    ds_read_b64_tr_b16 a[232:233], v188 offset:37120
    ds_read_b64_tr_b16 a[234:235], v188 offset:38144
    ds_read_b128 v[140:143], v171 offset:1024
    v_mfma_f32_32x32x16_bf16 v[48:63], a[236:239], a[32:35], v[48:63]
    buffer_load_dwordx4 v183, s[36:39], s72 offen offset:3072  lds
    s_add_u32 s72, s72, 128
    v_mfma_f32_32x32x16_bf16 v[112:127], a[236:239], a[36:39], v[112:127]
    ds_read_b64_tr_b16 a[236:237], v189 offset:37120
    ds_read_b64_tr_b16 a[238:239], v189 offset:38144
    ds_read_b128 v[144:147], v171 offset:2048
    s_waitcnt vmcnt(12) lgkmcnt(0)
    s_barrier
    s_add_u32 m0, s77, 16384
    v_mfma_f32_32x32x16_bf16 v[0:15], a[224:227], a[40:43], v[0:15]
    buffer_load_dwordx4 v184, s[40:43], s65 offen  lds
    v_mfma_f32_32x32x16_bf16 v[64:79], a[224:227], a[44:47], v[64:79]
    ds_read_b64_tr_b16 a[224:225], v188 offset:49152
    ds_read_b64_tr_b16 a[226:227], v188 offset:50176
    s_mul_i32 s93, s62, 2048
    v_mfma_f32_32x32x16_bf16 v[16:31], a[228:231], a[40:43], v[16:31]
    buffer_load_dwordx4 v185, s[40:43], s65 offen offset:1024  lds
    v_mfma_f32_32x32x16_bf16 v[80:95], a[228:231], a[44:47], v[80:95]
    ds_read_b64_tr_b16 a[228:229], v189 offset:49152
    ds_read_b64_tr_b16 a[230:231], v189 offset:50176
    s_add_u32 s93, s93, 11599872
    v_mfma_f32_32x32x16_bf16 v[32:47], a[232:235], a[40:43], v[32:47]
    buffer_load_dwordx4 v186, s[40:43], s65 offen offset:2048  lds
    v_mfma_f32_32x32x16_bf16 v[96:111], a[232:235], a[44:47], v[96:111]
    ds_read_b64_tr_b16 a[232:233], v188 offset:49408
    ds_read_b64_tr_b16 a[234:235], v188 offset:50432
    s_mul_i32 s89, s62, 229376
    s_mul_i32 s74, s56, 28672
    v_mfma_f32_32x32x16_bf16 v[48:63], a[236:239], a[40:43], v[48:63]
    buffer_load_dwordx4 v187, s[40:43], s65 offen offset:3072  lds
    s_add_u32 s65, s65, 114688
    v_mfma_f32_32x32x16_bf16 v[112:127], a[236:239], a[44:47], v[112:127]
    ds_read_b64_tr_b16 a[236:237], v189 offset:49408
    ds_read_b64_tr_b16 a[238:239], v189 offset:50432
    s_add_u32 s89, s89, s74
    s_add_u32 s89, s89, 16384
    s_add_u32 m0, s73, 98304
    s_waitcnt lgkmcnt(4)
    v_mfma_f32_32x32x16_bf16 v[0:15], a[224:227], a[48:51], v[0:15]
    buffer_load_dwordx4 v180, s[36:39], s72 offen  lds
    v_mfma_f32_32x32x16_bf16 v[64:79], a[224:227], a[52:55], v[64:79]
    ds_read_b64_tr_b16 a[224:225], v188 offset:53248
    ds_read_b64_tr_b16 a[226:227], v188 offset:54272
    v_accvgpr_read_b32 v148, a253
    v_mfma_f32_32x32x16_bf16 v[16:31], a[228:231], a[48:51], v[16:31]
    buffer_load_dwordx4 v181, s[36:39], s72 offen offset:1024  lds
    v_mfma_f32_32x32x16_bf16 v[80:95], a[228:231], a[52:55], v[80:95]
    ds_read_b64_tr_b16 a[228:229], v189 offset:53248
    ds_read_b64_tr_b16 a[230:231], v189 offset:54272
    s_waitcnt lgkmcnt(4)
    v_mfma_f32_32x32x16_bf16 v[32:47], a[232:235], a[48:51], v[32:47]
    buffer_load_dwordx4 v182, s[36:39], s72 offen offset:2048  lds
    v_mfma_f32_32x32x16_bf16 v[96:111], a[232:235], a[52:55], v[96:111]
    ds_read_b64_tr_b16 a[232:233], v188 offset:53504
    ds_read_b64_tr_b16 a[234:235], v188 offset:54528
    v_accvgpr_read_b32 v149, a254
    v_mfma_f32_32x32x16_bf16 v[48:63], a[236:239], a[48:51], v[48:63]
    buffer_load_dwordx4 v183, s[36:39], s72 offen offset:3072  lds
    s_add_u32 s72, s72, 128
    v_mfma_f32_32x32x16_bf16 v[112:127], a[236:239], a[52:55], v[112:127]
    ds_read_b64_tr_b16 a[236:237], v189 offset:53504
    ds_read_b64_tr_b16 a[238:239], v189 offset:54528
    v_add_f32 v148, v148, v145
    v_add_f32 v149, v149, v146
    s_waitcnt vmcnt(12)
    s_barrier
    s_add_u32 m0, s77, 32768
    s_waitcnt lgkmcnt(4)
    v_mfma_f32_32x32x16_bf16 v[0:15], a[224:227], a[56:59], v[0:15]
    buffer_load_dwordx4 v184, s[40:43], s65 offen  lds
    v_mfma_f32_32x32x16_bf16 v[64:79], a[224:227], a[60:63], v[64:79]
    ds_read_b64_tr_b16 a[224:225], v188 offset:0
    ds_read_b64_tr_b16 a[226:227], v188 offset:1024
    ds_read_b128 a[64:67], v172 offset:32768
    ds_read_b128 a[68:71], v172 offset:36864
    ds_read_b128 a[72:75], v173 offset:32768
    v_mfma_f32_32x32x16_bf16 v[16:31], a[228:231], a[56:59], v[16:31]
    buffer_load_dwordx4 v185, s[40:43], s65 offen offset:1024  lds
    v_mfma_f32_32x32x16_bf16 v[80:95], a[228:231], a[60:63], v[80:95]
    ds_read_b64_tr_b16 a[228:229], v189 offset:0
    ds_read_b64_tr_b16 a[230:231], v189 offset:1024
    s_waitcnt lgkmcnt(7)
    ds_read_b128 a[76:79], v173 offset:36864
    v_add_f32 v128, v128, v136
    v_mfma_f32_32x32x16_bf16 v[32:47], a[232:235], a[56:59], v[32:47]
    buffer_load_dwordx4 v186, s[40:43], s65 offen offset:2048  lds
    v_mfma_f32_32x32x16_bf16 v[96:111], a[232:235], a[60:63], v[96:111]
    ds_read_b64_tr_b16 a[232:233], v188 offset:256
    ds_read_b64_tr_b16 a[234:235], v188 offset:1280
    v_add_f32 v129, v129, v137
    v_add_f32 v130, v130, v138
    v_add_f32_e64 v131, v131, v139
    v_mfma_f32_32x32x16_bf16 v[48:63], a[236:239], a[56:59], v[48:63]
    buffer_load_dwordx4 v187, s[40:43], s65 offen offset:3072  lds
    s_add_u32 s65, s65, 114688
    v_mfma_f32_32x32x16_bf16 v[112:127], a[236:239], a[60:63], v[112:127]
    ds_read_b64_tr_b16 a[236:237], v189 offset:256
    ds_read_b64_tr_b16 a[238:239], v189 offset:1280
    v_add_f32 v132, v132, v140
    v_add_f32 v133, v133, v141
    v_add_f32 v134, v134, v142
    v_add_f32 v135, v135, v143
    s_add_u32 m0, s73, 114688
    s_waitcnt lgkmcnt(5)
    v_mfma_f32_32x32x16_bf16 v[0:15], a[224:227], a[64:67], v[0:15]
    buffer_load_dwordx4 v180, s[36:39], s72 offen  lds
    v_mfma_f32_32x32x16_bf16 v[64:79], a[224:227], a[68:71], v[64:79]
    ds_read_b64_tr_b16 a[224:225], v188 offset:4096
    ds_read_b64_tr_b16 a[226:227], v188 offset:5120
    ds_read_b128 a[80:83], v174 offset:32768
    ds_read_b128 a[84:87], v174 offset:36864
    ds_read_b128 a[88:91], v175 offset:32768
    v_mfma_f32_32x32x16_bf16 v[16:31], a[228:231], a[64:67], v[16:31]
    buffer_load_dwordx4 v181, s[36:39], s72 offen offset:1024  lds
    v_mfma_f32_32x32x16_bf16 v[80:95], a[228:231], a[68:71], v[80:95]
    ds_read_b64_tr_b16 a[228:229], v189 offset:4096
    ds_read_b64_tr_b16 a[230:231], v189 offset:5120
    s_waitcnt lgkmcnt(7)
    ds_read_b128 a[92:95], v175 offset:36864
    s_mul_i32 s86, s81, 114688
    v_mfma_f32_32x32x16_bf16 v[32:47], a[232:235], a[64:67], v[32:47]
    buffer_load_dwordx4 v182, s[36:39], s72 offen offset:2048  lds
    v_mfma_f32_32x32x16_bf16 v[96:111], a[232:235], a[68:71], v[96:111]
    ds_read_b64_tr_b16 a[232:233], v188 offset:4352
    ds_read_b64_tr_b16 a[234:235], v188 offset:5376
    s_lshl_b32 s74, s18, 12
    s_add_u32 s86, s86, s74
    s_add_u32 s87, s86, 114688
    v_mfma_f32_32x32x16_bf16 v[48:63], a[236:239], a[64:67], v[48:63]
    buffer_load_dwordx4 v183, s[36:39], s72 offen offset:3072  lds
    s_add_u32 s72, s72, 128
    v_mfma_f32_32x32x16_bf16 v[112:127], a[236:239], a[68:71], v[112:127]
    ds_read_b64_tr_b16 a[236:237], v189 offset:4352
    ds_read_b64_tr_b16 a[238:239], v189 offset:5376
    s_mul_i32 s74, s81, 1024
    s_lshl_b32 s75, s18, 2
    s_add_u32 s74, s74, s75
    s_add_u32 s92, s74, 11599872
    s_waitcnt vmcnt(12)
    s_barrier
    s_add_u32 m0, s77, 49152
    s_waitcnt lgkmcnt(5)
    v_mfma_f32_32x32x16_bf16 v[0:15], a[224:227], a[72:75], v[0:15]
    buffer_load_dwordx4 v184, s[40:43], s65 offen  lds
    v_mfma_f32_32x32x16_bf16 v[64:79], a[224:227], a[76:79], v[64:79]
    ds_read_b64_tr_b16 a[224:225], v188 offset:16384
    ds_read_b64_tr_b16 a[226:227], v188 offset:17408
    ds_read_b128 a[96:99], v172 offset:49152
    ds_read_b128 a[100:103], v172 offset:53248
    v_mfma_f32_32x32x16_bf16 v[16:31], a[228:231], a[72:75], v[16:31]
    buffer_load_dwordx4 v185, s[40:43], s65 offen offset:1024  lds
    v_mfma_f32_32x32x16_bf16 v[80:95], a[228:231], a[76:79], v[80:95]
    ds_read_b64_tr_b16 a[228:229], v189 offset:16384
    ds_read_b64_tr_b16 a[230:231], v189 offset:17408
    s_waitcnt lgkmcnt(6)
    ds_read_b128 a[104:107], v173 offset:49152
    ds_read_b128 a[108:111], v173 offset:53248
    v_mfma_f32_32x32x16_bf16 v[32:47], a[232:235], a[72:75], v[32:47]
    buffer_load_dwordx4 v186, s[40:43], s65 offen offset:2048  lds
    v_mfma_f32_32x32x16_bf16 v[96:111], a[232:235], a[76:79], v[96:111]
    ds_read_b64_tr_b16 a[232:233], v188 offset:16640
    ds_read_b64_tr_b16 a[234:235], v188 offset:17664
    v_cmp_eq_u32 vcc, 0, v255
    v_mov_b32 v140, s67
    v_cndmask_b32 v148, v148, v131, s[22:23]
    v_mfma_f32_32x32x16_bf16 v[48:63], a[236:239], a[72:75], v[48:63]
    buffer_load_dwordx4 v187, s[40:43], s65 offen offset:3072  lds
    s_add_u32 s65, s65, 114688
    v_mfma_f32_32x32x16_bf16 v[112:127], a[236:239], a[76:79], v[112:127]
    ds_read_b64_tr_b16 a[236:237], v189 offset:16640
    ds_read_b64_tr_b16 a[238:239], v189 offset:17664
    v_cndmask_b32 v149, v149, v132, s[22:23]
    v_cndmask_b32_e64 v140, 0, v140, vcc
    v_add_f32 v140, v128, v140
    s_add_u32 m0, s73, 131072
    s_waitcnt lgkmcnt(6)
    v_mfma_f32_32x32x16_bf16 v[0:15], a[224:227], a[80:83], v[0:15]
    buffer_load_dwordx4 v180, s[36:39], s72 offen  lds
    v_mfma_f32_32x32x16_bf16 v[64:79], a[224:227], a[84:87], v[64:79]
    ds_read_b64_tr_b16 a[224:225], v188 offset:20480
    ds_read_b64_tr_b16 a[226:227], v188 offset:21504
    ds_read_b128 a[112:115], v174 offset:49152
    v_mfma_f32_32x32x16_bf16 v[16:31], a[228:231], a[80:83], v[16:31]
    buffer_load_dwordx4 v181, s[36:39], s72 offen offset:1024  lds
    v_mfma_f32_32x32x16_bf16 v[80:95], a[228:231], a[84:87], v[80:95]
    ds_read_b64_tr_b16 a[228:229], v189 offset:20480
    ds_read_b64_tr_b16 a[230:231], v189 offset:21504
    s_waitcnt lgkmcnt(5)
    v_mfma_f32_32x32x16_bf16 v[32:47], a[232:235], a[80:83], v[32:47]
    buffer_load_dwordx4 v182, s[36:39], s72 offen offset:2048  lds
    v_mfma_f32_32x32x16_bf16 v[96:111], a[232:235], a[84:87], v[96:111]
    ds_read_b64_tr_b16 a[232:233], v188 offset:20736
    ds_read_b64_tr_b16 a[234:235], v188 offset:21760
    ds_read_b128 a[116:119], v174 offset:53248
    v_mfma_f32_32x32x16_bf16 v[48:63], a[236:239], a[80:83], v[48:63]
    buffer_load_dwordx4 v183, s[36:39], s72 offen offset:3072  lds
    s_add_u32 s72, s72, 128
    v_mfma_f32_32x32x16_bf16 v[112:127], a[236:239], a[84:87], v[112:127]
    ds_read_b64_tr_b16 a[236:237], v189 offset:20736
    ds_read_b64_tr_b16 a[238:239], v189 offset:21760
    ds_read_b128 a[120:123], v175 offset:49152
    ds_read_b128 a[124:127], v175 offset:53248
    s_waitcnt vmcnt(12)
    s_barrier
    s_add_u32 m0, s77, 0
    s_waitcnt lgkmcnt(7)
    v_mfma_f32_32x32x16_bf16 v[0:15], a[224:227], a[88:91], v[0:15]
    buffer_load_dwordx4 v184, s[40:43], s65 offen  lds
    v_mfma_f32_32x32x16_bf16 v[64:79], a[224:227], a[92:95], v[64:79]
    ds_read_b64_tr_b16 a[224:225], v188 offset:32768
    ds_read_b64_tr_b16 a[226:227], v188 offset:33792
    ds_read_b128 a[128:131], v176 offset:0
    ds_read_b128 a[132:135], v176 offset:4096
    ds_read_b128 a[136:139], v177 offset:0
    v_mfma_f32_32x32x16_bf16 v[16:31], a[228:231], a[88:91], v[16:31]
    buffer_load_dwordx4 v185, s[40:43], s65 offen offset:1024  lds
    v_mfma_f32_32x32x16_bf16 v[80:95], a[228:231], a[92:95], v[80:95]
    ds_read_b64_tr_b16 a[228:229], v189 offset:32768
    ds_read_b64_tr_b16 a[230:231], v189 offset:33792
    s_waitcnt lgkmcnt(9)
    ds_read_b128 a[140:143], v177 offset:4096
    s_mov_b32 s74, 0xaaaaaaaa
    v_mfma_f32_32x32x16_bf16 v[32:47], a[232:235], a[88:91], v[32:47]
    buffer_load_dwordx4 v186, s[40:43], s65 offen offset:2048  lds
    v_mfma_f32_32x32x16_bf16 v[96:111], a[232:235], a[92:95], v[96:111]
    ds_read_b64_tr_b16 a[232:233], v188 offset:33024
    ds_read_b64_tr_b16 a[234:235], v188 offset:34048
    s_mov_b32 s75, 0xaaaaaaaa
    v_cvt_pk_bf16_f32 v144, v149, v149
    v_cndmask_b32 v141, v148, v149, s[74:75]
    v_mfma_f32_32x32x16_bf16 v[48:63], a[236:239], a[88:91], v[48:63]
    buffer_load_dwordx4 v187, s[40:43], s65 offen offset:3072  lds
    s_add_u32 s65, s65, 114688
    v_mfma_f32_32x32x16_bf16 v[112:127], a[236:239], a[92:95], v[112:127]
    ds_read_b64_tr_b16 a[236:237], v189 offset:33024
    ds_read_b64_tr_b16 a[238:239], v189 offset:34048
    v_cvt_pk_bf16_f32 v146, v148, v148
    v_cvt_pk_bf16_f32 v147, v148, v148
    v_cvt_pk_bf16_f32 v145, v149, v141
    s_add_u32 m0, s73, 147456
    s_waitcnt lgkmcnt(5)
    v_mfma_f32_32x32x16_bf16 v[0:15], a[224:227], a[96:99], v[0:15]
    buffer_load_dwordx4 v200, s[44:47], s66 offen  lds
    v_mfma_f32_32x32x16_bf16 v[64:79], a[224:227], a[100:103], v[64:79]
    ds_read_b64_tr_b16 a[224:225], v188 offset:36864
    ds_read_b64_tr_b16 a[226:227], v188 offset:37888
    ds_read_b128 a[144:147], v178 offset:0
    v_mfma_f32_32x32x16_bf16 v[16:31], a[228:231], a[96:99], v[16:31]
    buffer_load_dwordx4 v201, s[44:47], s66 offen offset:1024  lds
    v_mfma_f32_32x32x16_bf16 v[80:95], a[228:231], a[100:103], v[80:95]
    ds_read_b64_tr_b16 a[228:229], v189 offset:36864
    ds_read_b64_tr_b16 a[230:231], v189 offset:37888
    s_waitcnt lgkmcnt(5)
    ds_read_b128 a[148:151], v178 offset:4096
    v_mfma_f32_32x32x16_bf16 v[32:47], a[232:235], a[96:99], v[32:47]
    buffer_load_dwordx4 v202, s[44:47], s66 offen offset:2048  lds
    v_mfma_f32_32x32x16_bf16 v[96:111], a[232:235], a[100:103], v[96:111]
    ds_read_b64_tr_b16 a[232:233], v188 offset:37120
    ds_read_b64_tr_b16 a[234:235], v188 offset:38144
    ds_read_b128 a[152:155], v179 offset:0
    ds_read_b128 a[156:159], v179 offset:4096
    v_mfma_f32_32x32x16_bf16 v[48:63], a[236:239], a[96:99], v[48:63]
    buffer_load_dwordx4 v203, s[44:47], s66 offen offset:3072  lds
    s_add_u32 s66, s66, 28672
    v_mfma_f32_32x32x16_bf16 v[112:127], a[236:239], a[100:103], v[112:127]
    ds_read_b64_tr_b16 a[236:237], v189 offset:37120
    ds_read_b64_tr_b16 a[238:239], v189 offset:38144
    global_load_dword v224, v225, s[32:33] sc1
    s_waitcnt vmcnt(13)
    s_barrier
    s_add_u32 m0, s77, 16384
    s_waitcnt lgkmcnt(7)
    v_mfma_f32_32x32x16_bf16 v[0:15], a[224:227], a[104:107], v[0:15]
    buffer_load_dwordx4 v184, s[40:43], s65 offen  lds
    v_mfma_f32_32x32x16_bf16 v[64:79], a[224:227], a[108:111], v[64:79]
    ds_read_b64_tr_b16 a[224:225], v188 offset:49152
    ds_read_b64_tr_b16 a[226:227], v188 offset:50176
    ds_read_b128 a[160:163], v176 offset:16384
    ds_read_b128 a[164:167], v176 offset:20480
    ds_read_b128 a[168:171], v177 offset:16384
    v_mfma_f32_32x32x16_bf16 v[16:31], a[228:231], a[104:107], v[16:31]
    buffer_load_dwordx4 v185, s[40:43], s65 offen offset:1024  lds
    v_mfma_f32_32x32x16_bf16 v[80:95], a[228:231], a[108:111], v[80:95]
    ds_read_b64_tr_b16 a[228:229], v189 offset:49152
    ds_read_b64_tr_b16 a[230:231], v189 offset:50176
    s_waitcnt lgkmcnt(7)
    ds_read_b128 a[172:175], v177 offset:20480
    v_cvt_pk_bf16_f32 v136, v135, v134
    v_mfma_f32_32x32x16_bf16 v[32:47], a[232:235], a[104:107], v[32:47]
    buffer_load_dwordx4 v186, s[40:43], s65 offen offset:2048  lds
    v_mfma_f32_32x32x16_bf16 v[96:111], a[232:235], a[108:111], v[96:111]
    ds_read_b64_tr_b16 a[232:233], v188 offset:49408
    ds_read_b64_tr_b16 a[234:235], v188 offset:50432
    v_cvt_pk_bf16_f32 v137, v133, v132
    v_cvt_pk_bf16_f32 v138, v131, v130
    v_cvt_pk_bf16_f32 v139, v129, v140
    v_mfma_f32_32x32x16_bf16 v[48:63], a[236:239], a[104:107], v[48:63]
    buffer_load_dwordx4 v187, s[40:43], s65 offen offset:3072  lds
    s_add_u32 s65, s65, 114688
    v_mfma_f32_32x32x16_bf16 v[112:127], a[236:239], a[108:111], v[112:127]
    ds_read_b64_tr_b16 a[236:237], v189 offset:49408
    ds_read_b64_tr_b16 a[238:239], v189 offset:50432
    v_cvt_pk_bf16_f32 v140, v130, v130
    v_cvt_pk_bf16_f32 v141, v129, v129
    v_cvt_pk_bf16_f32 v142, v129, v128
    v_cvt_pk_bf16_f32 v143, v128, v128
    s_add_u32 m0, s73, 65536
    s_waitcnt lgkmcnt(5)
    v_mfma_f32_32x32x16_bf16 v[0:15], a[224:227], a[112:115], v[0:15]
    buffer_load_dwordx4 v200, s[44:47], s66 offen  lds
    v_mfma_f32_32x32x16_bf16 v[64:79], a[224:227], a[116:119], v[64:79]
    ds_read_b64_tr_b16 a[224:225], v188 offset:53248
    ds_read_b64_tr_b16 a[226:227], v188 offset:54272
    ds_read_b128 a[176:179], v178 offset:16384
    v_mfma_f32_32x32x16_bf16 v[16:31], a[228:231], a[112:115], v[16:31]
    buffer_load_dwordx4 v201, s[44:47], s66 offen offset:1024  lds
    v_mfma_f32_32x32x16_bf16 v[80:95], a[228:231], a[116:119], v[80:95]
    ds_read_b64_tr_b16 a[228:229], v189 offset:53248
    ds_read_b64_tr_b16 a[230:231], v189 offset:54272
    s_waitcnt lgkmcnt(5)
    v_mfma_f32_32x32x16_bf16 v[32:47], a[232:235], a[112:115], v[32:47]
    buffer_load_dwordx4 v202, s[44:47], s66 offen offset:2048  lds
    v_mfma_f32_32x32x16_bf16 v[96:111], a[232:235], a[116:119], v[96:111]
    ds_read_b64_tr_b16 a[232:233], v188 offset:53504
    ds_read_b64_tr_b16 a[234:235], v188 offset:54528
    ds_read_b128 a[180:183], v178 offset:20480
    v_mfma_f32_32x32x16_bf16 v[48:63], a[236:239], a[112:115], v[48:63]
    buffer_load_dwordx4 v203, s[44:47], s66 offen offset:3072  lds
    s_add_u32 s66, s66, 28672
    v_mfma_f32_32x32x16_bf16 v[112:127], a[236:239], a[116:119], v[112:127]
    ds_read_b64_tr_b16 a[236:237], v189 offset:53504
    ds_read_b64_tr_b16 a[238:239], v189 offset:54528
    ds_read_b128 a[184:187], v179 offset:16384
    ds_read_b128 a[188:191], v179 offset:20480
    s_waitcnt vmcnt(13)
    s_barrier
    s_add_u32 m0, s77, 32768
    s_waitcnt lgkmcnt(7)
    v_mfma_f32_32x32x16_bf16 v[0:15], a[224:227], a[120:123], v[0:15]
    buffer_load_dwordx4 v184, s[40:43], s65 offen  lds
    v_mfma_f32_32x32x16_bf16 v[64:79], a[224:227], a[124:127], v[64:79]
    ds_read_b64_tr_b16 a[224:225], v188 offset:0
    ds_read_b64_tr_b16 a[226:227], v188 offset:1024
    ds_read_b128 a[192:195], v176 offset:32768
    ds_read_b128 a[196:199], v176 offset:36864
    v_mfma_f32_32x32x16_bf16 v[16:31], a[228:231], a[120:123], v[16:31]
    buffer_load_dwordx4 v185, s[40:43], s65 offen offset:1024  lds
    v_mfma_f32_32x32x16_bf16 v[80:95], a[228:231], a[124:127], v[80:95]
    ds_read_b64_tr_b16 a[228:229], v189 offset:0
    ds_read_b64_tr_b16 a[230:231], v189 offset:1024
    s_waitcnt lgkmcnt(8)
    ds_read_b128 a[200:203], v177 offset:32768
    v_mfma_f32_32x32x16_bf16 v[32:47], a[232:235], a[120:123], v[32:47]
    buffer_load_dwordx4 v186, s[40:43], s65 offen offset:2048  lds
    v_mfma_f32_32x32x16_bf16 v[96:111], a[232:235], a[124:127], v[96:111]
    ds_read_b64_tr_b16 a[232:233], v188 offset:256
    ds_read_b64_tr_b16 a[234:235], v188 offset:1280
    ds_read_b128 a[204:207], v177 offset:36864
    v_cndmask_b32 v136, v136, v140, s[22:23]
    v_mfma_f32_32x32x16_bf16 v[48:63], a[236:239], a[120:123], v[48:63]
    buffer_load_dwordx4 v187, s[40:43], s65 offen offset:3072  lds
    s_add_u32 s65, s65, 114688
    v_mfma_f32_32x32x16_bf16 v[112:127], a[236:239], a[124:127], v[112:127]
    ds_read_b64_tr_b16 a[236:237], v189 offset:256
    ds_read_b64_tr_b16 a[238:239], v189 offset:1280
    v_cndmask_b32 v137, v137, v141, s[22:23]
    v_cndmask_b32 v138, v138, v142, s[22:23]
    v_cndmask_b32 v139, v139, v143, s[22:23]
    s_waitcnt vmcnt(12)
    v_cmp_eq_u32 vcc, 0, v224
    s_cbranch_vccnz L_slow_nc
L_back_nc:
    v_readfirstlane_b32 s64, v224
    s_add_u32 m0, s73, 81920
    s_waitcnt lgkmcnt(6)
    v_mfma_f32_32x32x16_bf16 v[0:15], a[224:227], a[128:131], v[0:15]
    buffer_load_dwordx4 v200, s[44:47], s66 offen  lds
    v_mfma_f32_32x32x16_bf16 v[64:79], a[224:227], a[132:135], v[64:79]
    ds_read_b64_tr_b16 a[224:225], v188 offset:4096
    ds_read_b64_tr_b16 a[226:227], v188 offset:5120
    ds_read_b128 a[208:211], v178 offset:32768
    ds_read_b128 a[212:215], v178 offset:36864
    ds_read_b128 a[216:219], v179 offset:32768
    v_mfma_f32_32x32x16_bf16 v[16:31], a[228:231], a[128:131], v[16:31]
    buffer_load_dwordx4 v201, s[44:47], s66 offen offset:1024  lds
    v_mfma_f32_32x32x16_bf16 v[80:95], a[228:231], a[132:135], v[80:95]
    ds_read_b64_tr_b16 a[228:229], v189 offset:4096
    ds_read_b64_tr_b16 a[230:231], v189 offset:5120
    s_waitcnt lgkmcnt(7)
    ds_read_b128 a[220:223], v179 offset:36864
    v_mfma_f32_32x32x16_bf16 v[32:47], a[232:235], a[128:131], v[32:47]
    buffer_load_dwordx4 v202, s[44:47], s66 offen offset:2048  lds
    v_mfma_f32_32x32x16_bf16 v[96:111], a[232:235], a[132:135], v[96:111]
    ds_read_b64_tr_b16 a[232:233], v188 offset:4352
    ds_read_b64_tr_b16 a[234:235], v188 offset:5376
    ds_read_b64_tr_b16 a[0:1], v206 offset:16384
    ds_read_b64_tr_b16 a[2:3], v206 offset:17408
    ds_read_b64_tr_b16 a[4:5], v207 offset:16384
    ds_read_b64_tr_b16 a[6:7], v207 offset:17408
    v_mfma_f32_32x32x16_bf16 v[48:63], a[236:239], a[128:131], v[48:63]
    buffer_load_dwordx4 v203, s[44:47], s66 offen offset:3072  lds
    s_add_u32 s66, s66, 28672
    v_mfma_f32_32x32x16_bf16 v[112:127], a[236:239], a[132:135], v[112:127]
    ds_read_b64_tr_b16 a[236:237], v189 offset:4352
    ds_read_b64_tr_b16 a[238:239], v189 offset:5376
    ds_read_b64_tr_b16 a[8:9], v206 offset:18432
    ds_read_b64_tr_b16 a[10:11], v206 offset:19456
    ds_read_b64_tr_b16 a[12:13], v207 offset:18432
    ds_read_b64_tr_b16 a[14:15], v207 offset:19456
    s_waitcnt vmcnt(12)
    s_barrier
    s_add_u32 m0, s77, 49152
    s_waitcnt lgkmcnt(13)
    v_mfma_f32_32x32x16_bf16 v[0:15], a[224:227], a[136:139], v[0:15]
    buffer_load_dwordx4 v184, s[40:43], s65 offen  lds
    v_mfma_f32_32x32x16_bf16 v[64:79], a[224:227], a[140:143], v[64:79]
    ds_read_b64_tr_b16 a[224:225], v188 offset:16384
    ds_read_b64_tr_b16 a[226:227], v188 offset:17408
    s_mul_i32 s94, s61, 8320
    v_mfma_f32_32x32x16_bf16 v[16:31], a[228:231], a[136:139], v[16:31]
    buffer_load_dwordx4 v185, s[40:43], s65 offen offset:1024  lds
    v_mfma_f32_32x32x16_bf16 v[80:95], a[228:231], a[140:143], v[80:95]
    ds_read_b64_tr_b16 a[228:229], v189 offset:16384
    ds_read_b64_tr_b16 a[230:231], v189 offset:17408
    s_waitcnt lgkmcnt(8)
    v_mfma_f32_32x32x16_bf16 v[32:47], a[232:235], a[136:139], v[32:47]
    buffer_load_dwordx4 v186, s[40:43], s65 offen offset:2048  lds
    v_mfma_f32_32x32x16_bf16 v[96:111], a[232:235], a[140:143], v[96:111]
    ds_read_b64_tr_b16 a[232:233], v188 offset:16640
    ds_read_b64_tr_b16 a[234:235], v188 offset:17664
    s_lshl_b32 s74, s56, 11
    v_mfma_f32_32x32x16_bf16 v[48:63], a[236:239], a[136:139], v[48:63]
    buffer_load_dwordx4 v187, s[40:43], s65 offen offset:3072  lds
    s_add_u32 s65, s65, 114688
    v_mfma_f32_32x32x16_bf16 v[112:127], a[236:239], a[140:143], v[112:127]
    ds_read_b64_tr_b16 a[236:237], v189 offset:16640
    ds_read_b64_tr_b16 a[238:239], v189 offset:17664
    s_add_u32 s94, s94, s74
    s_add_u32 s94, s94, 9437184
    s_add_u32 m0, s73, 98304
    s_waitcnt lgkmcnt(4)
    v_mfma_f32_32x32x16_bf16 v[0:15], a[224:227], a[144:147], v[0:15]
    buffer_load_dwordx4 v200, s[44:47], s66 offen  lds
    v_mfma_f32_32x32x16_bf16 v[64:79], a[224:227], a[148:151], v[64:79]
    ds_read_b64_tr_b16 a[224:225], v188 offset:20480
    ds_read_b64_tr_b16 a[226:227], v188 offset:21504
    s_waitcnt vmcnt(13)
    ds_read_b64_tr_b16 a[16:17], v204 offset:0
    v_mfma_f32_32x32x16_bf16 v[16:31], a[228:231], a[144:147], v[16:31]
    buffer_load_dwordx4 v201, s[44:47], s66 offen offset:1024  lds
    v_mfma_f32_32x32x16_bf16 v[80:95], a[228:231], a[148:151], v[80:95]
    ds_read_b64_tr_b16 a[228:229], v189 offset:20480
    ds_read_b64_tr_b16 a[230:231], v189 offset:21504
    s_waitcnt lgkmcnt(5)
    ds_read_b64_tr_b16 a[18:19], v204 offset:1024
    v_mfma_f32_32x32x16_bf16 v[32:47], a[232:235], a[144:147], v[32:47]
    buffer_load_dwordx4 v202, s[44:47], s66 offen offset:2048  lds
    v_mfma_f32_32x32x16_bf16 v[96:111], a[232:235], a[148:151], v[96:111]
    ds_read_b64_tr_b16 a[232:233], v188 offset:20736
    ds_read_b64_tr_b16 a[234:235], v188 offset:21760
    ds_read_b64_tr_b16 a[20:21], v205 offset:0
    ds_read_b64_tr_b16 a[22:23], v205 offset:1024
    ds_read_b64_tr_b16 a[24:25], v204 offset:2048
    v_mfma_f32_32x32x16_bf16 v[48:63], a[236:239], a[144:147], v[48:63]
    buffer_load_dwordx4 v203, s[44:47], s66 offen offset:3072  lds
    s_add_u32 s66, s66, 28672
    v_mfma_f32_32x32x16_bf16 v[112:127], a[236:239], a[148:151], v[112:127]
    ds_read_b64_tr_b16 a[236:237], v189 offset:20736
    ds_read_b64_tr_b16 a[238:239], v189 offset:21760
    ds_read_b64_tr_b16 a[26:27], v204 offset:3072
    ds_read_b64_tr_b16 a[28:29], v205 offset:2048
    ds_read_b64_tr_b16 a[30:31], v205 offset:3072
    s_waitcnt vmcnt(12)
    s_barrier
    s_add_u32 m0, s77, 0
    s_waitcnt lgkmcnt(11)
    v_mfma_f32_32x32x16_bf16 v[0:15], a[224:227], a[152:155], v[0:15]
    buffer_load_dwordx4 v184, s[40:43], s65 offen  lds
    v_mfma_f32_32x32x16_bf16 v[64:79], a[224:227], a[156:159], v[64:79]
    ds_read_b64_tr_b16 a[224:225], v188 offset:32768
    ds_read_b64_tr_b16 a[226:227], v188 offset:33792
    v_mov_b32 v190, 0
    v_mfma_f32_32x32x16_bf16 v[16:31], a[228:231], a[152:155], v[16:31]
    buffer_load_dwordx4 v185, s[40:43], s65 offen offset:1024  lds
    v_mfma_f32_32x32x16_bf16 v[80:95], a[228:231], a[156:159], v[80:95]
    ds_read_b64_tr_b16 a[228:229], v189 offset:32768
    ds_read_b64_tr_b16 a[230:231], v189 offset:33792
    s_waitcnt lgkmcnt(7)
    v_mfma_f32_32x32x16_bf16 v[32:47], a[232:235], a[152:155], v[32:47]
    buffer_load_dwordx4 v186, s[40:43], s65 offen offset:2048  lds
    v_mfma_f32_32x32x16_bf16 v[96:111], a[232:235], a[156:159], v[96:111]
    ds_read_b64_tr_b16 a[232:233], v188 offset:33024
    ds_read_b64_tr_b16 a[234:235], v188 offset:34048
    v_mov_b32 v191, 0
    v_mfma_f32_32x32x16_bf16 v[48:63], a[236:239], a[152:155], v[48:63]
    buffer_load_dwordx4 v187, s[40:43], s65 offen offset:3072  lds
    s_add_u32 s65, s65, 114688
    v_mfma_f32_32x32x16_bf16 v[112:127], a[236:239], a[156:159], v[112:127]
    ds_read_b64_tr_b16 a[236:237], v189 offset:33024
    ds_read_b64_tr_b16 a[238:239], v189 offset:34048
    v_mov_b32_e64 v193, 0
    v_mov_b32 v194, 0
    s_add_u32 m0, s73, 114688
    s_waitcnt lgkmcnt(4)
    v_mfma_f32_32x32x16_bf16 v[0:15], a[224:227], a[160:163], v[0:15]
    buffer_load_dwordx4 v200, s[44:47], s66 offen  lds
    v_mfma_f32_32x32x16_bf16 v[64:79], a[224:227], a[164:167], v[64:79]
    ds_read_b64_tr_b16 a[224:225], v188 offset:36864
    ds_read_b64_tr_b16 a[226:227], v188 offset:37888
    s_waitcnt vmcnt(13)
    ds_read_b64_tr_b16 a[32:33], v204 offset:16384
    ds_read_b64_tr_b16 a[34:35], v204 offset:17408
    v_mfma_f32_32x32x16_bf16 v[16:31], a[228:231], a[160:163], v[16:31]
    buffer_load_dwordx4 v201, s[44:47], s66 offen offset:1024  lds
    v_mfma_f32_32x32x16_bf16 v[80:95], a[228:231], a[164:167], v[80:95]
    ds_read_b64_tr_b16 a[228:229], v189 offset:36864
    ds_read_b64_tr_b16 a[230:231], v189 offset:37888
    s_waitcnt lgkmcnt(6)
    ds_read_b64_tr_b16 a[36:37], v205 offset:16384
    ds_read_b64_tr_b16 a[38:39], v205 offset:17408
    v_mfma_f32_32x32x16_bf16 v[32:47], a[232:235], a[160:163], v[32:47]
    buffer_load_dwordx4 v202, s[44:47], s66 offen offset:2048  lds
    v_mfma_f32_32x32x16_bf16 v[96:111], a[232:235], a[164:167], v[96:111]
    ds_read_b64_tr_b16 a[232:233], v188 offset:37120
    ds_read_b64_tr_b16 a[234:235], v188 offset:38144
    ds_read_b64_tr_b16 a[40:41], v204 offset:18432
    ds_read_b64_tr_b16 a[42:43], v204 offset:19456
    ds_read_b64_tr_b16 a[44:45], v205 offset:18432
    v_mfma_f32_32x32x16_bf16 v[48:63], a[236:239], a[160:163], v[48:63]
    buffer_load_dwordx4 v203, s[44:47], s66 offen offset:3072  lds
    s_add_u32 s66, s66, 28672
    v_mfma_f32_32x32x16_bf16 v[112:127], a[236:239], a[164:167], v[112:127]
    ds_read_b64_tr_b16 a[236:237], v189 offset:37120
    ds_read_b64_tr_b16 a[238:239], v189 offset:38144
    ds_read_b64_tr_b16 a[46:47], v205 offset:19456
    buffer_load_dword v213, v210, s[48:51], s80 offen sc1
    s_waitcnt vmcnt(13)
    s_barrier
    s_add_u32 m0, s77, 16384
    s_waitcnt lgkmcnt(10)
    v_mfma_f32_32x32x16_bf16 v[0:15], a[224:227], a[168:171], v[0:15]
    buffer_load_dwordx4 v184, s[40:43], s65 offen  lds
    v_mfma_f32_32x32x16_bf16 v[64:79], a[224:227], a[172:175], v[64:79]
    ds_read_b64_tr_b16 a[224:225], v188 offset:49152
    ds_read_b64_tr_b16 a[226:227], v188 offset:50176
    v_mov_b32 v195, 0
    v_mfma_f32_32x32x16_bf16 v[16:31], a[228:231], a[168:171], v[16:31]
    buffer_load_dwordx4 v185, s[40:43], s65 offen offset:1024  lds
    v_mfma_f32_32x32x16_bf16 v[80:95], a[228:231], a[172:175], v[80:95]
    ds_read_b64_tr_b16 a[228:229], v189 offset:49152
    ds_read_b64_tr_b16 a[230:231], v189 offset:50176
    s_waitcnt lgkmcnt(5)
    v_mfma_f32_32x32x16_bf16 v[32:47], a[232:235], a[168:171], v[32:47]
    buffer_load_dwordx4 v186, s[40:43], s65 offen offset:2048  lds
    v_mfma_f32_32x32x16_bf16 v[96:111], a[232:235], a[172:175], v[96:111]
    ds_read_b64_tr_b16 a[232:233], v188 offset:49408
    ds_read_b64_tr_b16 a[234:235], v188 offset:50432
    v_mov_b32 v196, 0
    v_mfma_f32_32x32x16_bf16 v[48:63], a[236:239], a[168:171], v[48:63]
    buffer_load_dwordx4 v187, s[40:43], s65 offen offset:3072  lds
    s_add_u32 s65, s65, 114688
    v_mfma_f32_32x32x16_bf16 v[112:127], a[236:239], a[172:175], v[112:127]
    ds_read_b64_tr_b16 a[236:237], v189 offset:49408
    ds_read_b64_tr_b16 a[238:239], v189 offset:50432
    v_mov_b32_e64 v198, 0
    v_mov_b32 v199, 0
    s_add_u32 m0, s73, 131072
    s_waitcnt lgkmcnt(4)
    v_mfma_f32_32x32x16_bf16 v[0:15], a[224:227], a[176:179], v[0:15]
    buffer_load_dwordx4 v200, s[44:47], s66 offen  lds
    v_mfma_f32_32x32x16_bf16 v[64:79], a[224:227], a[180:183], v[64:79]
    ds_read_b64_tr_b16 a[224:225], v188 offset:53248
    ds_read_b64_tr_b16 a[226:227], v188 offset:54272
    s_waitcnt vmcnt(14)
    ds_read_b64_tr_b16 a[48:49], v204 offset:32768
    v_mfma_f32_32x32x16_bf16 v[16:31], a[228:231], a[176:179], v[16:31]
    buffer_load_dwordx4 v201, s[44:47], s66 offen offset:1024  lds
    v_mfma_f32_32x32x16_bf16 v[80:95], a[228:231], a[180:183], v[80:95]
    ds_read_b64_tr_b16 a[228:229], v189 offset:53248
    ds_read_b64_tr_b16 a[230:231], v189 offset:54272
    s_waitcnt lgkmcnt(5)
    ds_read_b64_tr_b16 a[50:51], v204 offset:33792
    v_mfma_f32_32x32x16_bf16 v[32:47], a[232:235], a[176:179], v[32:47]
    buffer_load_dwordx4 v202, s[44:47], s66 offen offset:2048  lds
    v_mfma_f32_32x32x16_bf16 v[96:111], a[232:235], a[180:183], v[96:111]
    ds_read_b64_tr_b16 a[232:233], v188 offset:53504
    ds_read_b64_tr_b16 a[234:235], v188 offset:54528
    ds_read_b64_tr_b16 a[52:53], v205 offset:32768
    ds_read_b64_tr_b16 a[54:55], v205 offset:33792
    ds_read_b64_tr_b16 a[56:57], v204 offset:34816
    v_mfma_f32_32x32x16_bf16 v[48:63], a[236:239], a[176:179], v[48:63]
    buffer_load_dwordx4 v203, s[44:47], s66 offen offset:3072  lds
    s_add_u32 s66, s66, 28672
    v_mfma_f32_32x32x16_bf16 v[112:127], a[236:239], a[180:183], v[112:127]
    ds_read_b64_tr_b16 a[236:237], v189 offset:53504
    ds_read_b64_tr_b16 a[238:239], v189 offset:54528
    ds_read_b64_tr_b16 a[58:59], v204 offset:35840
    ds_read_b64_tr_b16 a[60:61], v205 offset:34816
    ds_read_b64_tr_b16 a[62:63], v205 offset:35840
    s_waitcnt vmcnt(13)
    s_barrier
    s_waitcnt vmcnt(8)
    v_cmp_ne_u32 vcc, s64, v213
    s_cbranch_vccnz L_slow_fl
L_back_fl:
    s_waitcnt lgkmcnt(11)
    v_mfma_f32_32x32x16_bf16 v[0:15], a[224:227], a[184:187], v[0:15]
    buffer_load_dword v213, v211, s[48:51], s90 offen sc1
    v_mfma_f32_32x32x16_bf16 v[64:79], a[224:227], a[188:191], v[64:79]
    ds_read_b64_tr_b16 a[224:225], v188 offset:0
    ds_read_b64_tr_b16 a[226:227], v188 offset:1024
    v_mfma_f32_32x32x16_bf16 v[16:31], a[228:231], a[184:187], v[16:31]
    s_lshl_b32 s74, s97, 3
    s_add_u32 s74, s74, 11534340
    buffer_load_dword v228, v211, s[48:51], s74 offen sc1
    v_mfma_f32_32x32x16_bf16 v[80:95], a[228:231], a[188:191], v[80:95]
    ds_read_b64_tr_b16 a[228:229], v189 offset:0
    ds_read_b64_tr_b16 a[230:231], v189 offset:1024
    s_waitcnt lgkmcnt(7)
    v_mfma_f32_32x32x16_bf16 v[32:47], a[232:235], a[184:187], v[32:47]
    buffer_load_dwordx4 v[156:159], v212, s[48:51], s91 offen sc1
    v_mfma_f32_32x32x16_bf16 v[96:111], a[232:235], a[188:191], v[96:111]
    ds_read_b64_tr_b16 a[232:233], v188 offset:256
    ds_read_b64_tr_b16 a[234:235], v188 offset:1280
    v_mfma_f32_32x32x16_bf16 v[48:63], a[236:239], a[184:187], v[48:63]
    buffer_load_dword v154, v211, s[48:51], s90 offen offset:256 sc1
    v_mfma_f32_32x32x16_bf16 v[112:127], a[236:239], a[188:191], v[112:127]
    ds_read_b64_tr_b16 a[236:237], v189 offset:256
    ds_read_b64_tr_b16 a[238:239], v189 offset:1280
    s_add_u32 m0, s73, 147456
    s_waitcnt lgkmcnt(4)
    v_mfma_f32_32x32x16_bf16 v[0:15], a[224:227], a[192:195], v[0:15]
    buffer_load_dwordx4 v200, s[44:47], s66 offen  lds
    v_mfma_f32_32x32x16_bf16 v[64:79], a[224:227], a[196:199], v[64:79]
    ds_read_b64_tr_b16 a[224:225], v188 offset:4096
    ds_read_b64_tr_b16 a[226:227], v188 offset:5120
    ds_read_b64_tr_b16 a[64:65], v204 offset:49152
    ds_read_b64_tr_b16 a[66:67], v204 offset:50176
    v_mfma_f32_32x32x16_bf16 v[16:31], a[228:231], a[192:195], v[16:31]
    buffer_load_dwordx4 v201, s[44:47], s66 offen offset:1024  lds
    v_mfma_f32_32x32x16_bf16 v[80:95], a[228:231], a[196:199], v[80:95]
    ds_read_b64_tr_b16 a[228:229], v189 offset:4096
    ds_read_b64_tr_b16 a[230:231], v189 offset:5120
    s_waitcnt lgkmcnt(6)
    ds_read_b64_tr_b16 a[68:69], v205 offset:49152
    ds_read_b64_tr_b16 a[70:71], v205 offset:50176
    v_mfma_f32_32x32x16_bf16 v[32:47], a[232:235], a[192:195], v[32:47]
    buffer_load_dwordx4 v202, s[44:47], s66 offen offset:2048  lds
    s_waitcnt vmcnt(11)
    s_barrier
    v_mfma_f32_32x32x16_bf16 v[96:111], a[232:235], a[196:199], v[96:111]
    ds_read_b64_tr_b16 a[232:233], v188 offset:4352
    ds_read_b64_tr_b16 a[234:235], v188 offset:5376
    ds_read_b64_tr_b16 a[72:73], v204 offset:51200
    ds_read_b64_tr_b16 a[74:75], v204 offset:52224
    ds_read_b64_tr_b16 a[76:77], v205 offset:51200
    v_mfma_f32_32x32x16_bf16 v[48:63], a[236:239], a[192:195], v[48:63]
    buffer_load_dwordx4 v203, s[44:47], s66 offen offset:3072  lds
    s_add_u32 s66, s66, 28672
    ds_read_b64_tr_b16 a[144:145], v188 offset:16384
    ds_read_b64_tr_b16 a[146:147], v188 offset:17408
    v_mfma_f32_32x32x16_bf16 v[112:127], a[236:239], a[196:199], v[112:127]
    ds_read_b64_tr_b16 a[236:237], v189 offset:4352
    ds_read_b64_tr_b16 a[238:239], v189 offset:5376
    ds_read_b64_tr_b16 a[148:149], v188 offset:20480
    ds_read_b64_tr_b16 a[150:151], v188 offset:21504
    ds_read_b64_tr_b16 a[78:79], v205 offset:52224
    s_waitcnt lgkmcnt(15)
    v_mfma_f32_32x32x16_bf16 v[0:15], a[224:227], a[200:203], v[0:15]
    ds_read_b64_tr_b16 a[152:153], v189 offset:16384
    ds_read_b64_tr_b16 a[154:155], v189 offset:17408
    v_cmp_gt_u32 vcc, 32, v255
    v_mov_b32 v152, 0
    v_mov_b32 v153, 0
    s_add_u32 m0, s82, 5088
    s_nop 0
    buffer_load_dwordx4 v250, s[48:51], s83 offen sc1 lds
    s_waitcnt lgkmcnt(7)
    v_mfma_f32_32x32x16_bf16 v[0:15], a[144:147], a[208:211], v[0:15]
    ds_read_b64_tr_b16 a[156:157], v189 offset:20480
    ds_read_b64_tr_b16 a[158:159], v189 offset:21504
    s_waitcnt vmcnt(8)
    v_cndmask_b32 v192, 0, v213, vcc
    v_cndmask_b32 v197, 0, v213, vcc
    s_waitcnt lgkmcnt(5)
    v_mfma_f32_32x32x16_bf16 v[0:15], a[148:151], a[216:219], v[0:15]
    buffer_load_dwordx4 v250, s[48:51], s83 offen offset:1024 sc1 lds
    s_waitcnt vmcnt(7)
    v_mfma_f32_32x32x16_bf16 v[0:15], v[156:159], v[192:195], v[0:15]
    s_sub_u32 s83, s83, 2
    s_add_u32 m0, s82, 448
    v_mfma_f32_32x32x16_bf16 v[16:31], a[228:231], a[200:203], v[16:31]
    ds_read_b64_tr_b16 a[144:145], v188 offset:16640
    ds_read_b64_tr_b16 a[146:147], v188 offset:17664
    buffer_load_dwordx4 v250, s[48:51], s83 offen sc1 lds
    s_waitcnt lgkmcnt(4)
    v_mfma_f32_32x32x16_bf16 v[16:31], a[152:155], a[208:211], v[16:31]
    ds_read_b64_tr_b16 a[148:149], v188 offset:20736
    ds_read_b64_tr_b16 a[150:151], v188 offset:21760
    s_waitcnt lgkmcnt(4)
    v_mfma_f32_32x32x16_bf16 v[16:31], a[156:159], a[216:219], v[16:31]
    buffer_load_dwordx4 v250, s[48:51], s83 offen offset:1024 sc1 lds
    v_max_f32 v0, 0, v0
    v_max_f32 v1, 0, v1
    v_max_f32_e64 v2, 0, v2
    v_mfma_f32_32x32x16_bf16 v[16:31], v[156:159], v[196:199], v[16:31]
    v_max_f32 v3, 0, v3
    v_max_f32 v4, 0, v4
    v_max_f32 v5, 0, v5
    v_max_f32 v6, 0, v6
    v_max_f32 v7, 0, v7
    v_mul_f32 v0, v0, v8
    v_mul_f32 v1, v1, v9
    v_mul_f32 v2, v2, v10
    v_mfma_f32_32x32x16_bf16 v[32:47], a[232:235], a[200:203], v[32:47]
    ds_read_b64_tr_b16 a[152:153], v189 offset:16640
    ds_read_b64_tr_b16 a[154:155], v189 offset:17664
    v_mul_f32 v3, v3, v11
    v_mul_f32 v4, v4, v12
    v_mul_f32 v5, v5, v13
    v_mul_f32 v6, v6, v14
    v_mul_f32_e64 v7, v7, v15
    v_cvt_pk_bf16_f32 v8, v0, v1
    v_cvt_pk_bf16_f32 v9, v2, v3
    s_waitcnt lgkmcnt(4)
    v_mfma_f32_32x32x16_bf16 v[32:47], a[144:147], a[208:211], v[32:47]
    ds_read_b64_tr_b16 a[156:157], v189 offset:20736
    ds_read_b64_tr_b16 a[158:159], v189 offset:21760
    v_cvt_pk_bf16_f32 v10, v4, v5
    v_cvt_pk_bf16_f32 v11, v6, v7
    buffer_store_dwordx4 v[8:11], v250, s[48:51], s86 offen offset:0 sc1
    s_waitcnt lgkmcnt(4)
    v_mfma_f32_32x32x16_bf16 v[32:47], a[148:151], a[216:219], v[32:47]
    v_max_f32 v16, 0, v16
    v_max_f32 v17, 0, v17
    v_max_f32 v18, 0, v18
    v_max_f32 v19, 0, v19
    v_max_f32 v20, 0, v20
    v_max_f32 v21, 0, v21
    v_max_f32_e64 v22, 0, v22
    v_mfma_f32_32x32x16_bf16 v[32:47], v[156:159], v[190:193], v[32:47]
    v_max_f32 v23, 0, v23
    v_mul_f32 v16, v16, v24
    v_mul_f32 v17, v17, v25
    v_mul_f32 v18, v18, v26
    v_mul_f32 v19, v19, v27
    v_mul_f32 v20, v20, v28
    v_mul_f32_e64 v21, v21, v29
    v_mfma_f32_32x32x16_bf16 v[48:63], a[236:239], a[200:203], v[48:63]
    ds_read_b64_tr_b16 a[144:145], v188 offset:16384
    ds_read_b64_tr_b16 a[146:147], v188 offset:17408
    v_mul_f32 v22, v22, v30
    v_mul_f32 v23, v23, v31
    v_cvt_pk_bf16_f32 v24, v16, v17
    v_cvt_pk_bf16_f32 v25, v18, v19
    v_cvt_pk_bf16_f32 v26, v20, v21
    s_waitcnt lgkmcnt(4)
    v_mfma_f32_32x32x16_bf16 v[48:63], a[152:155], a[208:211], v[48:63]
    ds_read_b64_tr_b16 a[148:149], v188 offset:20480
    ds_read_b64_tr_b16 a[150:151], v188 offset:21504
    v_cvt_pk_bf16_f32 v27, v22, v23
    buffer_store_dwordx4 v[24:27], v250, s[48:51], s86 offen offset:1024 sc1
    s_waitcnt lgkmcnt(4)
    v_mfma_f32_32x32x16_bf16 v[48:63], a[156:159], a[216:219], v[48:63]
    v_max_f32 v32, 0, v32
    v_max_f32 v33, 0, v33
    v_max_f32 v34, 0, v34
    v_max_f32 v35, 0, v35
    v_max_f32 v36, 0, v36
    v_max_f32 v37, 0, v37
    v_max_f32_e64 v38, 0, v38
    v_mfma_f32_32x32x16_bf16 v[48:63], v[156:159], v[194:197], v[48:63]
    v_max_f32 v39, 0, v39
    v_mul_f32 v32, v32, v40
    v_mul_f32 v33, v33, v41
    v_mul_f32 v34, v34, v42
    v_mul_f32 v35, v35, v43
    v_mul_f32 v36, v36, v44
    v_mul_f32 v37, v37, v45
    v_mul_f32 v38, v38, v46
    v_mfma_f32_32x32x16_bf16 v[64:79], a[224:227], a[204:207], v[64:79]
    ds_read_b64_tr_b16 a[152:153], v189 offset:16384
    ds_read_b64_tr_b16 a[154:155], v189 offset:17408
    s_waitcnt vmcnt(10)
    v_cndmask_b32 v192, 0, v154, vcc
    v_cndmask_b32 v197, 0, v154, vcc
    v_mul_f32 v39, v39, v47
    v_cvt_pk_bf16_f32 v40, v32, v33
    v_cvt_pk_bf16_f32 v41, v34, v35
    v_cvt_pk_bf16_f32 v42, v36, v37
    s_waitcnt lgkmcnt(4)
    v_mfma_f32_32x32x16_bf16 v[64:79], a[144:147], a[212:215], v[64:79]
    ds_read_b64_tr_b16 a[156:157], v189 offset:20480
    ds_read_b64_tr_b16 a[158:159], v189 offset:21504
    v_cvt_pk_bf16_f32 v43, v38, v39
    buffer_store_dwordx4 v[40:43], v250, s[48:51], s86 offen offset:2048 sc1
    s_waitcnt lgkmcnt(4)
    v_mfma_f32_32x32x16_bf16 v[64:79], a[148:151], a[220:223], v[64:79]
    v_max_f32 v48, 0, v48
    v_max_f32 v49, 0, v49
    v_max_f32 v50, 0, v50
    v_max_f32 v51, 0, v51
    v_max_f32 v52, 0, v52
    v_max_f32 v53, 0, v53
    v_max_f32_e64 v54, 0, v54
    v_mfma_f32_32x32x16_bf16 v[64:79], v[156:159], v[192:195], v[64:79]
    v_max_f32 v55, 0, v55
    v_mul_f32 v48, v48, v56
    v_mul_f32 v49, v49, v57
    v_mul_f32 v50, v50, v58
    v_mul_f32 v51, v51, v59
    v_mul_f32 v52, v52, v60
    v_mul_f32_e64 v53, v53, v61
    v_mfma_f32_32x32x16_bf16 v[80:95], a[228:231], a[204:207], v[80:95]
    ds_read_b64_tr_b16 a[144:145], v188 offset:16640
    ds_read_b64_tr_b16 a[146:147], v188 offset:17664
    v_mul_f32 v54, v54, v62
    v_mul_f32 v55, v55, v63
    v_cvt_pk_bf16_f32 v56, v48, v49
    v_cvt_pk_bf16_f32 v57, v50, v51
    v_cvt_pk_bf16_f32 v58, v52, v53
    s_waitcnt lgkmcnt(4)
    v_mfma_f32_32x32x16_bf16 v[80:95], a[152:155], a[212:215], v[80:95]
    ds_read_b64_tr_b16 a[148:149], v188 offset:20736
    ds_read_b64_tr_b16 a[150:151], v188 offset:21760
    v_cvt_pk_bf16_f32 v59, v54, v55
    buffer_store_dwordx4 v[56:59], v250, s[48:51], s86 offen offset:3072 sc1
    s_waitcnt lgkmcnt(4)
    v_mfma_f32_32x32x16_bf16 v[80:95], a[156:159], a[220:223], v[80:95]
    v_max_f32 v64, 0, v64
    v_max_f32 v65, 0, v65
    v_max_f32 v66, 0, v66
    v_max_f32 v67, 0, v67
    v_max_f32 v68, 0, v68
    v_max_f32 v69, 0, v69
    v_max_f32_e64 v70, 0, v70
    v_mfma_f32_32x32x16_bf16 v[80:95], v[156:159], v[196:199], v[80:95]
    v_max_f32 v71, 0, v71
    v_mul_f32 v64, v64, v72
    v_mul_f32 v65, v65, v73
    v_mul_f32 v66, v66, v74
    v_mul_f32 v67, v67, v75
    v_mul_f32 v68, v68, v76
    v_mul_f32_e64 v69, v69, v77
    v_mfma_f32_32x32x16_bf16 v[96:111], a[232:235], a[204:207], v[96:111]
    ds_read_b64_tr_b16 a[152:153], v189 offset:16640
    ds_read_b64_tr_b16 a[154:155], v189 offset:17664
    v_mul_f32 v70, v70, v78
    v_mul_f32 v71, v71, v79
    v_cvt_pk_bf16_f32 v72, v64, v65
    v_cvt_pk_bf16_f32 v73, v66, v67
    v_cvt_pk_bf16_f32 v74, v68, v69
    s_waitcnt lgkmcnt(4)
    v_mfma_f32_32x32x16_bf16 v[96:111], a[144:147], a[212:215], v[96:111]
    ds_read_b64_tr_b16 a[156:157], v189 offset:20736
    ds_read_b64_tr_b16 a[158:159], v189 offset:21760
    v_cvt_pk_bf16_f32 v75, v70, v71
    buffer_store_dwordx4 v[72:75], v250, s[48:51], s87 offen offset:0 sc1
    s_waitcnt lgkmcnt(4)
    v_mfma_f32_32x32x16_bf16 v[96:111], a[148:151], a[220:223], v[96:111]
    v_max_f32 v80, 0, v80
    v_max_f32 v81, 0, v81
    v_max_f32 v82, 0, v82
    v_max_f32 v83, 0, v83
    v_max_f32 v84, 0, v84
    v_max_f32 v85, 0, v85
    v_mfma_f32_32x32x16_bf16 v[96:111], v[156:159], v[190:193], v[96:111]
    v_max_f32 v86, 0, v86
    v_max_f32 v87, 0, v87
    v_mul_f32 v80, v80, v88
    v_mul_f32 v81, v81, v89
    v_mul_f32 v82, v82, v90
    v_mul_f32 v83, v83, v91
    v_mfma_f32_32x32x16_bf16 v[112:127], a[236:239], a[204:207], v[112:127]
    v_mul_f32 v84, v84, v92
    v_mul_f32 v85, v85, v93
    v_mul_f32 v86, v86, v94
    v_mul_f32 v87, v87, v95
    v_cvt_pk_bf16_f32 v88, v80, v81
    v_cvt_pk_bf16_f32 v89, v82, v83
    s_waitcnt lgkmcnt(2)
    v_mfma_f32_32x32x16_bf16 v[112:127], a[152:155], a[212:215], v[112:127]
    v_cvt_pk_bf16_f32 v90, v84, v85
    v_cvt_pk_bf16_f32 v91, v86, v87
    buffer_store_dwordx4 v[88:91], v250, s[48:51], s87 offen offset:1024 sc1
    s_waitcnt lgkmcnt(0)
    v_mfma_f32_32x32x16_bf16 v[112:127], a[156:159], a[220:223], v[112:127]
    v_max_f32 v96, 0, v96
    v_max_f32 v97, 0, v97
    v_max_f32 v98, 0, v98
    v_max_f32 v99, 0, v99
    v_mfma_f32_32x32x16_bf16 v[112:127], v[156:159], v[194:197], v[112:127]
    v_max_f32 v100, 0, v100
    v_max_f32 v101, 0, v101
    v_max_f32_e64 v102, 0, v102
    v_max_f32 v103, 0, v103
    s_barrier
    v_pk_mul_f32 v[96:97], v[96:97], v[104:105]
    ds_write_b128 v163, v[136:139] offset:0
    v_pk_mul_f32 v[98:99], v[98:99], v[106:107]
    ds_write2_b64 v161, v[136:137], v[138:139] offset0:0 offset1:1
    v_pk_mul_f32 v[100:101], v[100:101], v[108:109]
    v_pk_mul_f32 v[102:103], v[102:103], v[110:111]
    ds_write2_b32 v160, v136, v137 offset0:0 offset1:1
    v_cvt_pk_bf16_f32 v104, v96, v97
    v_cvt_pk_bf16_f32 v105, v98, v99
    ds_write2_b32 v160, v138, v139 offset0:2 offset1:3
    v_cvt_pk_bf16_f32 v106, v100, v101
    v_cvt_pk_bf16_f32 v107, v102, v103
    ds_write2_b32 v162, v136, v137 offset0:0 offset1:1
    buffer_store_dwordx4 v[104:107], v250, s[48:51], s87 offen offset:2048 sc1
    v_max_f32_e64 v112, 0, v112
    ds_write2_b32 v162, v138, v139 offset0:2 offset1:3
    v_max_f32 v113, 0, v113
    v_max_f32 v114, 0, v114
    ds_write_b128 v167, v[144:147] offset:0
    v_max_f32 v115, 0, v115
    v_max_f32 v116, 0, v116
    ds_write2_b64 v165, v[144:145], v[146:147] offset0:0 offset1:1
    v_max_f32_e64 v117, 0, v117
    ds_write2_b32 v164, v144, v145 offset0:0 offset1:1
    v_max_f32 v118, 0, v118
    v_max_f32 v119, 0, v119
    ds_write2_b32 v164, v146, v147 offset0:2 offset1:3
    v_pk_mul_f32 v[112:113], v[112:113], v[120:121]
    v_pk_mul_f32 v[114:115], v[114:115], v[122:123]
    ds_write2_b32 v166, v144, v145 offset0:0 offset1:1
    v_pk_mul_f32 v[116:117], v[116:117], v[124:125]
    v_pk_mul_f32 v[118:119], v[118:119], v[126:127]
    ds_write2_b32 v166, v146, v147 offset0:2 offset1:3
    v_cvt_pk_bf16_f32 v120, v112, v113
    v_cvt_pk_bf16_f32 v121, v114, v115
    ds_write_b32 v168, v152 offset:4084
    v_cvt_pk_bf16_f32 v122, v116, v117
    v_cvt_pk_bf16_f32 v123, v118, v119
    ds_write_b64 v169, v[152:153]
    buffer_store_dwordx4 v[120:123], v250, s[48:51], s87 offen offset:3072 sc1
    s_andn2_b64 exec, 1, s[22:23]
    s_waitcnt vmcnt(8)
    ds_write_b16 v169, v152 offset:448
    s_mov_b64 exec, -1
    s_waitcnt lgkmcnt(0)
    s_barrier
    ds_read_b128 a[128:131], v209 offset:3968
    ds_read_b128 v[0:3], v208 offset:384
    ds_read_b128 v[16:19], v208 offset:896
    ds_read_b128 v[32:35], v208 offset:1408
    ds_read_b128 v[48:51], v208 offset:1920
    ds_read_b128 v[64:67], v208 offset:2432
    ds_read_b128 v[80:83], v208 offset:2944
    ds_read_b128 v[96:99], v208 offset:3456
    ds_read_b128 v[112:115], v208 offset:3968
    ds_read_b128 a[132:135], v209 offset:3840
    ds_read_b128 a[136:139], v209 offset:3712
    s_waitcnt lgkmcnt(9)
    v_mfma_f32_16x16x32_bf16 a[224:227], a[128:131], v[0:3], 0
    s_add_u32 m0, s73, 65536
    s_nop 0
    buffer_load_dwordx4 v200, s[44:47], s66 offen  lds
    s_waitcnt lgkmcnt(8)
    v_mfma_f32_16x16x32_bf16 a[228:231], a[128:131], v[16:19], 0
    ds_read_b128 a[140:143], v209 offset:3584
    s_waitcnt lgkmcnt(8)
    v_mfma_f32_16x16x32_bf16 a[232:235], a[128:131], v[32:35], 0
    ds_read_b128 v[4:7], v208 offset:256
    s_waitcnt lgkmcnt(8)
    v_mfma_f32_16x16x32_bf16 a[236:239], a[128:131], v[48:51], 0
    ds_read_b128 v[20:23], v208 offset:768
    s_waitcnt lgkmcnt(8)
    v_mfma_f32_16x16x32_bf16 a[240:243], a[128:131], v[64:67], 0
    buffer_load_dwordx4 v201, s[44:47], s66 offen offset:1024  lds
    s_waitcnt lgkmcnt(7)
    v_mfma_f32_16x16x32_bf16 a[244:247], a[128:131], v[80:83], 0
    ds_read_b128 v[36:39], v208 offset:1280
    ds_read_b128 v[52:55], v208 offset:1792
    s_waitcnt lgkmcnt(8)
    v_mfma_f32_16x16x32_bf16 a[248:251], a[128:131], v[96:99], 0
    ds_read_b128 v[68:71], v208 offset:2304
    ds_read_b128 v[84:87], v208 offset:2816
    s_waitcnt lgkmcnt(9)
    v_mfma_f32_16x16x32_bf16 a[252:255], a[128:131], v[112:115], 0
    ds_read_b128 v[100:103], v208 offset:3328
    ds_read_b128 v[116:119], v208 offset:3840
    s_waitcnt lgkmcnt(7)
    v_mfma_f32_16x16x32_bf16 a[224:227], a[132:135], v[4:7], a[224:227]
    buffer_load_dwordx4 v202, s[44:47], s66 offen offset:2048  lds
    s_waitcnt lgkmcnt(6)
    v_mfma_f32_16x16x32_bf16 a[228:231], a[132:135], v[20:23], a[228:231]
    ds_read_b128 a[128:131], v209 offset:3456
    s_waitcnt lgkmcnt(6)
    v_mfma_f32_16x16x32_bf16 a[232:235], a[132:135], v[36:39], a[232:235]
    ds_read_b128 v[8:11], v208 offset:128
    s_waitcnt lgkmcnt(6)
    v_mfma_f32_16x16x32_bf16 a[236:239], a[132:135], v[52:55], a[236:239]
    ds_read_b128 v[24:27], v208 offset:640
    s_waitcnt lgkmcnt(6)
    v_mfma_f32_16x16x32_bf16 a[240:243], a[132:135], v[68:71], a[240:243]
    buffer_load_dwordx4 v203, s[44:47], s66 offen offset:3072  lds
    s_add_u32 s66, s66, 28672
    s_add_u32 m0, s73, 81920
    s_waitcnt lgkmcnt(5)
    v_mfma_f32_16x16x32_bf16 a[244:247], a[132:135], v[84:87], a[244:247]
    ds_read_b128 v[40:43], v208 offset:1152
    ds_read_b128 v[56:59], v208 offset:1664
    s_waitcnt lgkmcnt(6)
    v_mfma_f32_16x16x32_bf16 a[248:251], a[132:135], v[100:103], a[248:251]
    ds_read_b128 v[72:75], v208 offset:2176
    ds_read_b128 v[88:91], v208 offset:2688
    s_waitcnt lgkmcnt(7)
    v_mfma_f32_16x16x32_bf16 a[252:255], a[132:135], v[116:119], a[252:255]
    ds_read_b128 v[104:107], v208 offset:3200
    ds_read_b128 v[120:123], v208 offset:3712
    s_waitcnt lgkmcnt(7)
    v_mfma_f32_16x16x32_bf16 a[224:227], a[136:139], v[8:11], a[224:227]
    buffer_load_dwordx4 v200, s[44:47], s66 offen  lds
    s_waitcnt lgkmcnt(6)
    v_mfma_f32_16x16x32_bf16 a[228:231], a[136:139], v[24:27], a[228:231]
    ds_read_b128 a[132:135], v209 offset:3328
    ds_read_b128 v[12:15], v208 offset:0
    s_waitcnt lgkmcnt(7)
    v_mfma_f32_16x16x32_bf16 a[232:235], a[136:139], v[40:43], a[232:235]
    ds_read_b128 v[28:31], v208 offset:512
    ds_read_b128 v[44:47], v208 offset:1024
    s_waitcnt lgkmcnt(8)
    v_mfma_f32_16x16x32_bf16 a[236:239], a[136:139], v[56:59], a[236:239]
    ds_read_b128 v[60:63], v208 offset:1536
    ds_read_b128 v[76:79], v208 offset:2048
    s_waitcnt lgkmcnt(9)
    v_mfma_f32_16x16x32_bf16 a[240:243], a[136:139], v[72:75], a[240:243]
    buffer_load_dwordx4 v201, s[44:47], s66 offen offset:1024  lds
    s_waitcnt lgkmcnt(8)
    v_mfma_f32_16x16x32_bf16 a[244:247], a[136:139], v[88:91], a[244:247]
    ds_read_b128 v[92:95], v208 offset:2560
    ds_read_b128 v[108:111], v208 offset:3072
    s_waitcnt lgkmcnt(9)
    v_mfma_f32_16x16x32_bf16 a[248:251], a[136:139], v[104:107], a[248:251]
    ds_read_b128 v[124:127], v208 offset:3584
    v_mul_u32_u24 v155, 1024, v255
    s_waitcnt vmcnt(6)
    s_waitcnt lgkmcnt(9)
    v_mfma_f32_16x16x32_bf16 a[252:255], a[136:139], v[120:123], a[252:255]
    s_mov_b64 exec, 3
    buffer_store_dword v224, v155, s[48:51], s92 offen sc1
    s_mov_b64 exec, -1
    s_waitcnt lgkmcnt(7)
    v_mfma_f32_16x16x32_bf16 a[224:227], a[140:143], v[12:15], a[224:227]
    buffer_load_dwordx4 v202, s[44:47], s66 offen offset:2048  lds
    s_waitcnt lgkmcnt(6)
    v_mfma_f32_16x16x32_bf16 a[228:231], a[140:143], v[28:31], a[228:231]
    ds_read_b128 a[136:139], v209 offset:3200
    s_waitcnt lgkmcnt(6)
    v_mfma_f32_16x16x32_bf16 a[232:235], a[140:143], v[44:47], a[232:235]
    s_waitcnt lgkmcnt(5)
    v_mfma_f32_16x16x32_bf16 a[236:239], a[140:143], v[60:63], a[236:239]
    ds_read_b64_tr_b16 a[80:81], v206 offset:0
    ds_read_b64_tr_b16 a[82:83], v206 offset:1024
    s_waitcnt lgkmcnt(6)
    v_mfma_f32_16x16x32_bf16 a[240:243], a[140:143], v[76:79], a[240:243]
    buffer_load_dwordx4 v203, s[44:47], s66 offen offset:3072  lds
    s_add_u32 s66, s66, 28672
    s_add_u32 m0, s73, 98304
    s_waitcnt lgkmcnt(5)
    v_mfma_f32_16x16x32_bf16 a[244:247], a[140:143], v[92:95], a[244:247]
    ds_read_b64_tr_b16 a[84:85], v207 offset:0
    ds_read_b64_tr_b16 a[86:87], v207 offset:1024
    s_waitcnt lgkmcnt(6)
    v_mfma_f32_16x16x32_bf16 a[248:251], a[140:143], v[108:111], a[248:251]
    ds_read_b64_tr_b16 a[88:89], v206 offset:2048
    ds_read_b64_tr_b16 a[90:91], v206 offset:3072
    s_waitcnt lgkmcnt(7)
    v_mfma_f32_16x16x32_bf16 a[252:255], a[140:143], v[124:127], a[252:255]
    ds_read_b64_tr_b16 a[92:93], v207 offset:2048
    ds_read_b64_tr_b16 a[94:95], v207 offset:3072
    v_mfma_f32_16x16x32_bf16 a[228:231], a[128:131], v[0:3], a[228:231]
    buffer_load_dwordx4 v200, s[44:47], s66 offen  lds
    v_mfma_f32_16x16x32_bf16 a[232:235], a[128:131], v[16:19], a[232:235]
    ds_read_b128 a[140:143], v209 offset:3072
    v_mfma_f32_16x16x32_bf16 a[236:239], a[128:131], v[32:35], a[236:239]
    ds_read_b64_tr_b16 a[96:97], v206 offset:16384
    ds_read_b64_tr_b16 a[98:99], v206 offset:17408
    v_mfma_f32_16x16x32_bf16 a[240:243], a[128:131], v[48:51], a[240:243]
    buffer_load_dwordx4 v201, s[44:47], s66 offen offset:1024  lds
    v_mfma_f32_16x16x32_bf16 a[244:247], a[128:131], v[64:67], a[244:247]
    ds_read_b64_tr_b16 a[100:101], v207 offset:16384
    ds_read_b64_tr_b16 a[102:103], v207 offset:17408
    v_mfma_f32_16x16x32_bf16 a[248:251], a[128:131], v[80:83], a[248:251]
    ds_read_b64_tr_b16 a[104:105], v206 offset:18432
    ds_read_b64_tr_b16 a[106:107], v206 offset:19456
    v_mfma_f32_16x16x32_bf16 a[252:255], a[128:131], v[96:99], a[252:255]
    ds_read_b64_tr_b16 a[108:109], v207 offset:18432
    ds_read_b64_tr_b16 a[110:111], v207 offset:19456
    s_barrier
    v_mfma_f32_16x16x32_bf16 a[228:231], a[132:135], v[4:7], a[228:231]
    buffer_load_dwordx4 v202, s[44:47], s66 offen offset:2048  lds
    v_mfma_f32_16x16x32_bf16 a[232:235], a[132:135], v[20:23], a[232:235]
    v_mfma_f32_16x16x32_bf16 a[236:239], a[132:135], v[36:39], a[236:239]
    v_mfma_f32_16x16x32_bf16 a[240:243], a[132:135], v[52:55], a[240:243]
    buffer_load_dwordx4 v203, s[44:47], s66 offen offset:3072  lds
    s_add_u32 s66, s66, 28672
    s_add_u32 m0, s73, 114688
    v_mfma_f32_16x16x32_bf16 a[244:247], a[132:135], v[68:71], a[244:247]
    v_mfma_f32_16x16x32_bf16 a[248:251], a[132:135], v[84:87], a[248:251]
    v_mfma_f32_16x16x32_bf16 a[252:255], a[132:135], v[100:103], a[252:255]
    ds_read_b128 a[128:131], v209 offset:2944
    s_waitcnt lgkmcnt(15)
    v_mfma_f32_16x16x32_bf16 a[228:231], a[136:139], v[8:11], a[228:231]
    buffer_load_dwordx4 v200, s[44:47], s66 offen  lds
    v_mfma_f32_16x16x32_bf16 a[232:235], a[136:139], v[24:27], a[232:235]
    ds_read_b128 a[132:135], v209 offset:2816
    s_waitcnt vmcnt(10)
    v_mfma_f32_16x16x32_bf16 a[236:239], a[136:139], v[40:43], a[236:239]
    ds_read_b64_tr_b16 a[112:113], v204 offset:0
    ds_read_b64_tr_b16 a[114:115], v204 offset:1024
    v_mfma_f32_16x16x32_bf16 a[240:243], a[136:139], v[56:59], a[240:243]
    buffer_load_dwordx4 v201, s[44:47], s66 offen offset:1024  lds
    v_mfma_f32_16x16x32_bf16 a[244:247], a[136:139], v[72:75], a[244:247]
    ds_read_b64_tr_b16 a[116:117], v205 offset:0
    ds_read_b64_tr_b16 a[118:119], v205 offset:1024
    v_mfma_f32_16x16x32_bf16 a[248:251], a[136:139], v[88:91], a[248:251]
    ds_read_b64_tr_b16 a[120:121], v204 offset:2048
    ds_read_b64_tr_b16 a[122:123], v204 offset:3072
    v_mfma_f32_16x16x32_bf16 a[252:255], a[136:139], v[104:107], a[252:255]
    ds_read_b64_tr_b16 a[124:125], v205 offset:2048
    ds_read_b64_tr_b16 a[126:127], v205 offset:3072
    s_waitcnt lgkmcnt(15)
    v_mfma_f32_16x16x32_bf16 a[228:231], a[140:143], v[12:15], a[228:231]
    buffer_load_dwordx4 v202, s[44:47], s66 offen offset:2048  lds
    v_mfma_f32_16x16x32_bf16 a[232:235], a[140:143], v[28:31], a[232:235]
    v_mfma_f32_16x16x32_bf16 a[236:239], a[140:143], v[44:47], a[236:239]
    v_mfma_f32_16x16x32_bf16 a[240:243], a[140:143], v[60:63], a[240:243]
    buffer_load_dwordx4 v203, s[44:47], s66 offen offset:3072  lds
    s_add_u32 s66, s66, 28672
    s_add_u32 m0, s73, 131072
    v_mfma_f32_16x16x32_bf16 a[244:247], a[140:143], v[76:79], a[244:247]
    v_mfma_f32_16x16x32_bf16 a[248:251], a[140:143], v[92:95], a[248:251]
    v_mfma_f32_16x16x32_bf16 a[252:255], a[140:143], v[108:111], a[252:255]
    ds_read_b128 a[136:139], v209 offset:2688
    s_waitcnt lgkmcnt(10)
    v_mfma_f32_16x16x32_bf16 a[232:235], a[128:131], v[0:3], a[232:235]
    buffer_load_dwordx4 v200, s[44:47], s66 offen  lds
    v_mfma_f32_16x16x32_bf16 a[236:239], a[128:131], v[16:19], a[236:239]
    v_mfma_f32_16x16x32_bf16 a[240:243], a[128:131], v[32:35], a[240:243]
    v_mfma_f32_16x16x32_bf16 a[244:247], a[128:131], v[48:51], a[244:247]
    buffer_load_dwordx4 v201, s[44:47], s66 offen offset:1024  lds
    v_mfma_f32_16x16x32_bf16 a[248:251], a[128:131], v[64:67], a[248:251]
    v_mfma_f32_16x16x32_bf16 a[252:255], a[128:131], v[80:83], a[252:255]
    ds_read_b128 a[140:143], v209 offset:2560
    s_waitcnt lgkmcnt(10)
    v_mfma_f32_16x16x32_bf16 a[232:235], a[132:135], v[4:7], a[232:235]
    buffer_load_dwordx4 v202, s[44:47], s66 offen offset:2048  lds
    v_mfma_f32_16x16x32_bf16 a[236:239], a[132:135], v[20:23], a[236:239]
    v_mfma_f32_16x16x32_bf16 a[240:243], a[132:135], v[36:39], a[240:243]
    v_mfma_f32_16x16x32_bf16 a[244:247], a[132:135], v[52:55], a[244:247]
    buffer_load_dwordx4 v203, s[44:47], s66 offen offset:3072  lds
    s_add_u32 s66, s66, 28672
    s_add_u32 m0, s73, 147456
    v_mfma_f32_16x16x32_bf16 a[248:251], a[132:135], v[68:71], a[248:251]
    v_mfma_f32_16x16x32_bf16 a[252:255], a[132:135], v[84:87], a[252:255]
    ds_read_b128 a[128:131], v209 offset:2432
    s_waitcnt lgkmcnt(2)
    v_mfma_f32_16x16x32_bf16 a[232:235], a[136:139], v[8:11], a[232:235]
    buffer_load_dwordx4 v200, s[44:47], s66 offen  lds
    v_mfma_f32_16x16x32_bf16 a[236:239], a[136:139], v[24:27], a[236:239]
    v_mfma_f32_16x16x32_bf16 a[240:243], a[136:139], v[40:43], a[240:243]
    v_mfma_f32_16x16x32_bf16 a[244:247], a[136:139], v[56:59], a[244:247]
    buffer_load_dwordx4 v201, s[44:47], s66 offen offset:1024  lds
    v_mfma_f32_16x16x32_bf16 a[248:251], a[136:139], v[72:75], a[248:251]
    v_mfma_f32_16x16x32_bf16 a[252:255], a[136:139], v[88:91], a[252:255]
    ds_read_b128 a[132:135], v209 offset:2304
    s_waitcnt lgkmcnt(2)
    v_mfma_f32_16x16x32_bf16 a[232:235], a[140:143], v[12:15], a[232:235]
    buffer_load_dwordx4 v202, s[44:47], s66 offen offset:2048  lds
    v_mfma_f32_16x16x32_bf16 a[236:239], a[140:143], v[28:31], a[236:239]
    v_mfma_f32_16x16x32_bf16 a[240:243], a[140:143], v[44:47], a[240:243]
    v_mfma_f32_16x16x32_bf16 a[244:247], a[140:143], v[60:63], a[244:247]
    buffer_load_dwordx4 v203, s[44:47], s66 offen offset:3072  lds
    s_add_u32 s66, s66, 28672
    s_add_u32 m0, s73, 65536
    v_mfma_f32_16x16x32_bf16 a[248:251], a[140:143], v[76:79], a[248:251]
    v_mfma_f32_16x16x32_bf16 a[252:255], a[140:143], v[92:95], a[252:255]
    ds_read_b128 a[136:139], v209 offset:2176
    s_waitcnt lgkmcnt(2)
    v_mfma_f32_16x16x32_bf16 a[236:239], a[128:131], v[0:3], a[236:239]
    buffer_load_dwordx4 v200, s[44:47], s66 offen  lds
    v_mfma_f32_16x16x32_bf16 a[240:243], a[128:131], v[16:19], a[240:243]
    v_mfma_f32_16x16x32_bf16 a[244:247], a[128:131], v[32:35], a[244:247]
    buffer_load_dwordx4 v201, s[44:47], s66 offen offset:1024  lds
    v_mfma_f32_16x16x32_bf16 a[248:251], a[128:131], v[48:51], a[248:251]
    v_mfma_f32_16x16x32_bf16 a[252:255], a[128:131], v[64:67], a[252:255]
    ds_read_b128 a[140:143], v209 offset:2048
    s_waitcnt lgkmcnt(2)
    v_mfma_f32_16x16x32_bf16 a[236:239], a[132:135], v[4:7], a[236:239]
    buffer_load_dwordx4 v202, s[44:47], s66 offen offset:2048  lds
    v_mfma_f32_16x16x32_bf16 a[240:243], a[132:135], v[20:23], a[240:243]
    v_mfma_f32_16x16x32_bf16 a[244:247], a[132:135], v[36:39], a[244:247]
    buffer_load_dwordx4 v203, s[44:47], s66 offen offset:3072  lds
    s_add_u32 s66, s66, 28672
    v_mfma_f32_16x16x32_bf16 a[248:251], a[132:135], v[52:55], a[248:251]
    v_mfma_f32_16x16x32_bf16 a[252:255], a[132:135], v[68:71], a[252:255]
    ds_read_b128 a[128:131], v209 offset:1920
    s_waitcnt lgkmcnt(2)
    v_mfma_f32_16x16x32_bf16 a[236:239], a[136:139], v[8:11], a[236:239]
    v_mfma_f32_16x16x32_bf16 a[240:243], a[136:139], v[24:27], a[240:243]
    v_mfma_f32_16x16x32_bf16 a[244:247], a[136:139], v[40:43], a[244:247]
    v_mfma_f32_16x16x32_bf16 a[248:251], a[136:139], v[56:59], a[248:251]
    v_mfma_f32_16x16x32_bf16 a[252:255], a[136:139], v[72:75], a[252:255]
    ds_read_b128 a[132:135], v209 offset:1792
    s_waitcnt lgkmcnt(2)
    v_mfma_f32_16x16x32_bf16 a[236:239], a[140:143], v[12:15], a[236:239]
    v_mfma_f32_16x16x32_bf16 a[240:243], a[140:143], v[28:31], a[240:243]
    v_mfma_f32_16x16x32_bf16 a[244:247], a[140:143], v[44:47], a[244:247]
    v_mfma_f32_16x16x32_bf16 a[248:251], a[140:143], v[60:63], a[248:251]
    v_mfma_f32_16x16x32_bf16 a[252:255], a[140:143], v[76:79], a[252:255]
    ds_read_b128 a[136:139], v209 offset:1664
    s_waitcnt lgkmcnt(2)
    v_mfma_f32_16x16x32_bf16 a[240:243], a[128:131], v[0:3], a[240:243]
    v_mfma_f32_16x16x32_bf16 a[244:247], a[128:131], v[16:19], a[244:247]
    ds_read_b128 a[140:143], v209 offset:1536
    v_mfma_f32_16x16x32_bf16 a[248:251], a[128:131], v[32:35], a[248:251]
    buffer_load_dword v213, v217, s[48:51], s93 offen sc1
    v_mfma_f32_16x16x32_bf16 a[252:255], a[128:131], v[48:51], a[252:255]
    ds_write_b128 v214, a[224:227] offset:4096
    s_waitcnt lgkmcnt(3)
    v_mfma_f32_16x16x32_bf16 a[240:243], a[132:135], v[4:7], a[240:243]
    v_mfma_f32_16x16x32_bf16 a[244:247], a[132:135], v[20:23], a[244:247]
    v_mfma_f32_16x16x32_bf16 a[248:251], a[132:135], v[36:39], a[248:251]
    ds_read_b128 a[128:131], v209 offset:1408
    v_mfma_f32_16x16x32_bf16 a[252:255], a[132:135], v[52:55], a[252:255]
    ds_write_b128 v214, a[228:231] offset:8192
    s_waitcnt lgkmcnt(4)
    v_mfma_f32_16x16x32_bf16 a[240:243], a[136:139], v[8:11], a[240:243]
    v_mfma_f32_16x16x32_bf16 a[244:247], a[136:139], v[24:27], a[244:247]
    v_mfma_f32_16x16x32_bf16 a[248:251], a[136:139], v[40:43], a[248:251]
    ds_read_b128 a[132:135], v209 offset:1280
    v_mfma_f32_16x16x32_bf16 a[252:255], a[136:139], v[56:59], a[252:255]
    ds_write_b128 v214, a[232:235] offset:12288
    s_waitcnt lgkmcnt(5)
    v_mfma_f32_16x16x32_bf16 a[240:243], a[140:143], v[12:15], a[240:243]
    v_mfma_f32_16x16x32_bf16 a[244:247], a[140:143], v[28:31], a[244:247]
    v_mfma_f32_16x16x32_bf16 a[248:251], a[140:143], v[44:47], a[248:251]
    ds_read_b128 a[136:139], v209 offset:1152
    v_mfma_f32_16x16x32_bf16 a[252:255], a[140:143], v[60:63], a[252:255]
    ds_write_b128 v214, a[236:239] offset:16384
    s_waitcnt vmcnt(0)
    v_cmp_ne_u32 vcc, s64, v213
    s_cbranch_vccnz L_slow_fh
L_back_fh:
    s_waitcnt lgkmcnt(5)
    v_mfma_f32_16x16x32_bf16 a[244:247], a[128:131], v[0:3], a[244:247]
    v_mfma_f32_16x16x32_bf16 a[248:251], a[128:131], v[16:19], a[248:251]
    ds_read_b128 a[140:143], v209 offset:1024
    v_mfma_f32_16x16x32_bf16 a[252:255], a[128:131], v[32:35], a[252:255]
    buffer_load_dwordx4 v[96:99], v218, s[48:51], s89 offen offset:0 sc1
    s_waitcnt lgkmcnt(4)
    v_mfma_f32_16x16x32_bf16 a[244:247], a[132:135], v[4:7], a[244:247]
    ds_read_b128 a[128:131], v209 offset:896
    v_mfma_f32_16x16x32_bf16 a[248:251], a[132:135], v[20:23], a[248:251]
    ds_write_b128 v214, a[240:243] offset:20480
    v_mfma_f32_16x16x32_bf16 a[252:255], a[132:135], v[36:39], a[252:255]
    buffer_load_dwordx4 v[100:103], v219, s[48:51], s89 offen offset:0 sc1
    s_waitcnt lgkmcnt(4)
    v_mfma_f32_16x16x32_bf16 a[244:247], a[136:139], v[8:11], a[244:247]
    v_mfma_f32_16x16x32_bf16 a[248:251], a[136:139], v[24:27], a[248:251]
    ds_read_b128 a[132:135], v209 offset:768
    v_mfma_f32_16x16x32_bf16 a[252:255], a[136:139], v[40:43], a[252:255]
    buffer_load_dwordx4 v[104:107], v218, s[48:51], s89 offen offset:1024 sc1
    s_waitcnt lgkmcnt(3)
    v_mfma_f32_16x16x32_bf16 a[244:247], a[140:143], v[12:15], a[244:247]
    v_mfma_f32_16x16x32_bf16 a[248:251], a[140:143], v[28:31], a[248:251]
    ds_read_b128 a[136:139], v209 offset:640
    v_mfma_f32_16x16x32_bf16 a[252:255], a[140:143], v[44:47], a[252:255]
    buffer_load_dwordx4 v[108:111], v219, s[48:51], s89 offen offset:1024 sc1
    s_waitcnt lgkmcnt(3)
    v_mfma_f32_16x16x32_bf16 a[248:251], a[128:131], v[0:3], a[248:251]
    ds_read_b128 a[140:143], v209 offset:512
    v_mfma_f32_16x16x32_bf16 a[252:255], a[128:131], v[16:19], a[252:255]
    buffer_load_dwordx4 v[112:115], v218, s[48:51], s89 offen offset:2048 sc1
    s_waitcnt lgkmcnt(2)
    v_mfma_f32_16x16x32_bf16 a[248:251], a[132:135], v[4:7], a[248:251]
    ds_read_b128 a[128:131], v209 offset:384
    ds_write_b128 v214, a[244:247] offset:24576
    v_mfma_f32_16x16x32_bf16 a[252:255], a[132:135], v[20:23], a[252:255]
    buffer_load_dwordx4 v[116:119], v219, s[48:51], s89 offen offset:2048 sc1
    s_waitcnt lgkmcnt(3)
    v_mfma_f32_16x16x32_bf16 a[248:251], a[136:139], v[8:11], a[248:251]
    ds_read_b128 a[132:135], v209 offset:256
    v_mfma_f32_16x16x32_bf16 a[252:255], a[136:139], v[24:27], a[252:255]
    buffer_load_dwordx4 v[120:123], v218, s[48:51], s89 offen offset:3072 sc1
    s_waitcnt lgkmcnt(3)
    v_mfma_f32_16x16x32_bf16 a[248:251], a[140:143], v[12:15], a[248:251]
    ds_read_b128 a[136:139], v209 offset:128
    v_mfma_f32_16x16x32_bf16 a[252:255], a[140:143], v[28:31], a[252:255]
    buffer_load_dwordx4 v[124:127], v219, s[48:51], s89 offen offset:3072 sc1
    s_add_u32 s89, s89, 4096
    s_waitcnt lgkmcnt(3)
    v_mfma_f32_16x16x32_bf16 a[252:255], a[128:131], v[0:3], a[252:255]
    ds_read_b128 a[140:143], v209 offset:0
    buffer_load_dwordx4 v[128:131], v218, s[48:51], s89 offen offset:0 sc1
    s_waitcnt lgkmcnt(2)
    v_mfma_f32_16x16x32_bf16 a[252:255], a[132:135], v[4:7], a[252:255]
    ds_write_b128 v214, a[248:251] offset:28672
    buffer_load_dwordx4 v[132:135], v219, s[48:51], s89 offen offset:0 sc1
    s_waitcnt lgkmcnt(2)
    v_mfma_f32_16x16x32_bf16 a[252:255], a[136:139], v[8:11], a[252:255]
    buffer_load_dwordx4 v[136:139], v218, s[48:51], s89 offen offset:1024 sc1
    s_waitcnt lgkmcnt(1)
    v_mfma_f32_16x16x32_bf16 a[252:255], a[140:143], v[12:15], a[252:255]
    buffer_load_dwordx4 v[140:143], v219, s[48:51], s89 offen offset:1024 sc1
    ds_read_b64_tr_b16 a[128:129], v204 offset:16384
    ds_read_b64_tr_b16 a[130:131], v204 offset:17408
    ds_read_b64_tr_b16 a[132:133], v205 offset:16384
    ds_read_b64_tr_b16 a[134:135], v205 offset:17408
    s_nop 2
    ds_write_b128 v214, a[252:255] offset:0
    s_waitcnt vmcnt(11) lgkmcnt(3)
    v_mfma_f32_32x32x16_bf16 v[0:15], a[128:131], v[96:99], 0
    ds_read_b64_tr_b16 a[136:137], v204 offset:18432
    ds_read_b64_tr_b16 a[138:139], v204 offset:19456
    ds_read_b64_tr_b16 a[140:141], v205 offset:18432
    ds_read_b64_tr_b16 a[142:143], v205 offset:19456
    s_waitcnt lgkmcnt(4)
    s_barrier
    ds_read_b64 v[64:65], v215 offset:0
    ds_read_b64 v[66:67], v215 offset:16
    ds_read_b64 v[68:69], v215 offset:1024
    v_mfma_f32_32x32x16_bf16 v[16:31], a[132:135], v[96:99], 0
    buffer_load_dwordx4 v[144:147], v218, s[48:51], s89 offen offset:2048 sc1
    ds_read_b64 v[70:71], v215 offset:1040
    ds_read_b64 v[72:73], v215 offset:2048
    ds_read_b64 v[74:75], v215 offset:2064
    ds_read_b64 v[76:77], v215 offset:3072
    s_waitcnt vmcnt(11)
    v_mfma_f32_32x32x16_bf16 v[32:47], a[128:131], v[100:103], 0
    buffer_load_dwordx4 v[148:151], v219, s[48:51], s89 offen offset:2048 sc1
    ds_read_b64 v[78:79], v215 offset:3088
    ds_read_b64 v[80:81], v216 offset:0
    ds_read_b64 v[82:83], v216 offset:16
    ds_read_b64 v[84:85], v216 offset:1024
    v_mfma_f32_32x32x16_bf16 v[48:63], a[132:135], v[100:103], 0
    buffer_load_dwordx4 v[152:155], v218, s[48:51], s89 offen offset:3072 sc1
    ds_read_b64 v[86:87], v216 offset:1040
    ds_read_b64 v[88:89], v216 offset:2048
    ds_read_b64 v[90:91], v216 offset:2064
    ds_read_b64 v[92:93], v216 offset:3072
    ds_read_b64 v[94:95], v216 offset:3088
    s_waitcnt vmcnt(12) lgkmcnt(15)
    v_mfma_f32_32x32x16_bf16 v[0:15], a[136:139], v[104:107], v[0:15]
    ds_read_b64_tr_b16 a[128:129], v204 offset:32768
    ds_read_b64_tr_b16 a[130:131], v204 offset:33792
    ds_read_b64_tr_b16 a[132:133], v205 offset:32768
    ds_read_b64_tr_b16 a[134:135], v205 offset:33792
    s_waitcnt lgkmcnt(15)
    v_add_f32 v64, v64, v68
    v_add_f32 v65, v65, v69
    v_add_f32 v66, v66, v70
    v_add_f32_e64 v67, v67, v71
    v_mfma_f32_32x32x16_bf16 v[16:31], a[140:143], v[104:107], v[16:31]
    buffer_load_dwordx4 v[156:159], v219, s[48:51], s89 offen offset:3072 sc1
    s_add_u32 s89, s89, 4096
    s_waitcnt lgkmcnt(13)
    v_add_f32 v72, v72, v76
    v_add_f32 v73, v73, v77
    s_waitcnt lgkmcnt(12)
    v_add_f32 v74, v74, v78
    s_waitcnt vmcnt(12)
    v_mfma_f32_32x32x16_bf16 v[32:47], a[136:139], v[108:111], v[32:47]
    buffer_load_dwordx4 v[96:99], v218, s[48:51], s89 offen offset:0 sc1
    v_add_f32_e64 v75, v75, v79
    v_cvt_pk_bf16_f32 v68, v64, v72
    v_cvt_pk_bf16_f32 v69, v66, v74
    v_cvt_pk_bf16_f32 v70, v65, v73
    v_cvt_pk_bf16_f32 v71, v67, v75
    v_mfma_f32_32x32x16_bf16 v[48:63], a[140:143], v[108:111], v[48:63]
    buffer_load_dwordx4 v[100:103], v219, s[48:51], s89 offen offset:0 sc1
    buffer_store_dwordx4 v[68:71], v250, s[48:51], s94 offen offset:0 sc1
    s_waitcnt vmcnt(14) lgkmcnt(2)
    v_mfma_f32_32x32x16_bf16 v[0:15], a[128:131], v[112:115], v[0:15]
    ds_read_b64_tr_b16 a[136:137], v204 offset:34816
    ds_read_b64_tr_b16 a[138:139], v204 offset:35840
    ds_read_b64_tr_b16 a[140:141], v205 offset:34816
    ds_read_b64_tr_b16 a[142:143], v205 offset:35840
    v_add_f32 v80, v80, v84
    v_add_f32_e64 v81, v81, v85
    v_add_f32 v82, v82, v86
    s_waitcnt lgkmcnt(4)
    v_mfma_f32_32x32x16_bf16 v[16:31], a[132:135], v[112:115], v[16:31]
    buffer_load_dwordx4 v[104:107], v218, s[48:51], s89 offen offset:1024 sc1
    v_add_f32 v83, v83, v87
    v_add_f32 v88, v88, v92
    v_add_f32 v89, v89, v93
    s_waitcnt vmcnt(14)
    v_mfma_f32_32x32x16_bf16 v[32:47], a[128:131], v[116:119], v[32:47]
    buffer_load_dwordx4 v[108:111], v219, s[48:51], s89 offen offset:1024 sc1
    v_add_f32 v90, v90, v94
    v_add_f32 v91, v91, v95
    v_cvt_pk_bf16_f32 v84, v80, v88
    v_mfma_f32_32x32x16_bf16 v[48:63], a[132:135], v[116:119], v[48:63]
    v_cvt_pk_bf16_f32 v85, v82, v90
    v_cvt_pk_bf16_f32 v86, v81, v89
    v_cvt_pk_bf16_f32 v87, v83, v91
    buffer_store_dwordx4 v[84:87], v250, s[48:51], s94 offen offset:1024 sc1
    s_waitcnt vmcnt(15) lgkmcnt(2)
    v_mfma_f32_32x32x16_bf16 v[0:15], a[136:139], v[120:123], v[0:15]
    ds_read_b64_tr_b16 a[128:129], v204 offset:49152
    s_waitcnt lgkmcnt(1)
    v_mfma_f32_32x32x16_bf16 v[16:31], a[140:143], v[120:123], v[16:31]
    buffer_load_dwordx4 v[112:115], v218, s[48:51], s89 offen offset:2048 sc1
    s_waitcnt vmcnt(15)
    v_mfma_f32_32x32x16_bf16 v[32:47], a[136:139], v[124:127], v[32:47]
    buffer_load_dwordx4 v[116:119], v219, s[48:51], s89 offen offset:2048 sc1
    v_mfma_f32_32x32x16_bf16 v[48:63], a[140:143], v[124:127], v[48:63]
    ds_read_b64_tr_b16 a[130:131], v204 offset:50176
    ds_read_b64_tr_b16 a[132:133], v205 offset:49152
    ds_read_b64_tr_b16 a[134:135], v205 offset:50176
    s_waitcnt vmcnt(15) lgkmcnt(2)
    v_mfma_f32_32x32x16_bf16 v[0:15], a[128:131], v[128:131], v[0:15]
    ds_read_b64_tr_b16 a[136:137], v204 offset:51200
    ds_read_b64_tr_b16 a[138:139], v204 offset:52224
    ds_read_b64_tr_b16 a[140:141], v205 offset:51200
    ds_read_b64_tr_b16 a[142:143], v205 offset:52224
    s_lshr_b32 s74, s61, 5
    s_lshl_b32 s74, s74, 2
    s_waitcnt lgkmcnt(4)
    v_mfma_f32_32x32x16_bf16 v[16:31], a[132:135], v[128:131], v[16:31]
    buffer_load_dwordx4 v[120:123], v218, s[48:51], s89 offen offset:3072 sc1
    s_waitcnt vmcnt(15)
    v_mfma_f32_32x32x16_bf16 v[32:47], a[128:131], v[132:135], v[32:47]
    buffer_load_dwordx4 v[124:127], v219, s[48:51], s89 offen offset:3072 sc1
    s_sub_u32 s89, s89, 24576
    v_mfma_f32_32x32x16_bf16 v[48:63], a[132:135], v[132:135], v[48:63]
    s_add_u32 s74, s74, s56
    s_mul_i32 s74, s74, 1024
    s_and_b32 s75, s61, 31
    s_lshl_b32 s75, s75, 2
    s_add_u32 s74, s74, s75
    s_add_u32 s95, s74, 11665408
    s_waitcnt vmcnt(15) lgkmcnt(2)
    v_mfma_f32_32x32x16_bf16 v[0:15], a[136:139], v[136:139], v[0:15]
    ds_read_b64_tr_b16 a[128:129], v206 offset:0
    ds_read_b64_tr_b16 a[130:131], v206 offset:1024
    ds_read_b64_tr_b16 a[132:133], v207 offset:0
    ds_read_b64_tr_b16 a[134:135], v207 offset:1024
    s_waitcnt lgkmcnt(4)
    v_mfma_f32_32x32x16_bf16 v[16:31], a[140:143], v[136:139], v[16:31]
    buffer_load_dwordx4 v[128:131], v218, s[48:51], s89 offen offset:0 sc1
    s_waitcnt vmcnt(15)
    v_mfma_f32_32x32x16_bf16 v[32:47], a[136:139], v[140:143], v[32:47]
    buffer_load_dwordx4 v[132:135], v219, s[48:51], s89 offen offset:0 sc1
    v_mfma_f32_32x32x16_bf16 v[48:63], a[140:143], v[140:143], v[48:63]
    s_lshl_b32 s80, s63, 2
    s_lshr_b32 s74, s62, 3
    s_add_u32 s80, s80, s74
    s_mul_i32 s80, s80, 1024
    s_add_u32 s80, s80, 11665408
    s_add_u32 s13, s73, 65536
    v_add_u32 v230, s13, v250
    s_waitcnt vmcnt(15) lgkmcnt(2)
    v_mfma_f32_32x32x16_bf16 v[0:15], a[128:131], v[144:147], v[0:15]
    ds_read_b64_tr_b16 a[136:137], v206 offset:2048
    ds_read_b64_tr_b16 a[138:139], v206 offset:3072
    ds_read_b64_tr_b16 a[140:141], v207 offset:2048
    ds_read_b64_tr_b16 a[142:143], v207 offset:3072
    s_waitcnt vmcnt(6)
    s_waitcnt lgkmcnt(4)
    v_mfma_f32_32x32x16_bf16 v[16:31], a[132:135], v[144:147], v[16:31]
    buffer_load_dwordx4 v[136:139], v218, s[48:51], s89 offen offset:1024 sc1
    v_mfma_f32_32x32x16_bf16 v[32:47], a[128:131], v[148:151], v[32:47]
    buffer_load_dwordx4 v[140:143], v219, s[48:51], s89 offen offset:1024 sc1
    v_mfma_f32_32x32x16_bf16 v[48:63], a[132:135], v[148:151], v[48:63]
    s_mov_b64 exec, 1
    buffer_store_dword v224, v225, s[48:51], s95 offen sc1
    s_mov_b64 exec, -1
    s_waitcnt lgkmcnt(2)
    v_mfma_f32_32x32x16_bf16 v[0:15], a[136:139], v[152:155], v[0:15]
    ds_read_b64_tr_b16 a[128:129], v206 offset:16384
    s_waitcnt lgkmcnt(1)
    v_mfma_f32_32x32x16_bf16 v[16:31], a[140:143], v[152:155], v[16:31]
    buffer_load_dwordx4 v[144:147], v218, s[48:51], s89 offen offset:2048 sc1
    v_mfma_f32_32x32x16_bf16 v[32:47], a[136:139], v[156:159], v[32:47]
    buffer_load_dwordx4 v[148:151], v219, s[48:51], s89 offen offset:2048 sc1
    v_mfma_f32_32x32x16_bf16 v[48:63], a[140:143], v[156:159], v[48:63]
    ds_read_b64_tr_b16 a[130:131], v206 offset:17408
    ds_read_b64_tr_b16 a[132:133], v207 offset:16384
    ds_read_b64_tr_b16 a[134:135], v207 offset:17408
    s_waitcnt lgkmcnt(2)
    v_mfma_f32_32x32x16_bf16 v[0:15], a[128:131], v[96:99], v[0:15]
    ds_read_b64_tr_b16 a[136:137], v206 offset:18432
    ds_read_b64_tr_b16 a[138:139], v206 offset:19456
    s_waitcnt lgkmcnt(2)
    v_mfma_f32_32x32x16_bf16 v[16:31], a[132:135], v[96:99], v[16:31]
    buffer_load_dwordx4 v[152:155], v218, s[48:51], s89 offen offset:3072 sc1
    v_mfma_f32_32x32x16_bf16 v[32:47], a[128:131], v[100:103], v[32:47]
    buffer_load_dwordx4 v[156:159], v219, s[48:51], s89 offen offset:3072 sc1
    s_add_u32 s89, s89, 4096
    v_mfma_f32_32x32x16_bf16 v[48:63], a[132:135], v[100:103], v[48:63]
    ds_read_b64_tr_b16 a[140:141], v207 offset:18432
    ds_read_b64_tr_b16 a[142:143], v207 offset:19456
    s_waitcnt lgkmcnt(2)
    v_mfma_f32_32x32x16_bf16 v[0:15], a[136:139], v[104:107], v[0:15]
    ds_read_b64_tr_b16 a[128:129], v204 offset:0
    ds_read_b64_tr_b16 a[130:131], v204 offset:1024
    ds_read_b64_tr_b16 a[132:133], v205 offset:0
    ds_read_b64_tr_b16 a[134:135], v205 offset:1024
    s_waitcnt lgkmcnt(4)
    v_mfma_f32_32x32x16_bf16 v[16:31], a[140:143], v[104:107], v[16:31]
    buffer_load_dwordx4 v[96:99], v218, s[48:51], s89 offen offset:0 sc1
    v_mfma_f32_32x32x16_bf16 v[32:47], a[136:139], v[108:111], v[32:47]
    buffer_load_dwordx4 v[100:103], v219, s[48:51], s89 offen offset:0 sc1
    v_mfma_f32_32x32x16_bf16 v[48:63], a[140:143], v[108:111], v[48:63]
    ds_write_b128 v230, v[242:245] offset:49152
    v_mul_u32_u24 v234, 224, v210
    v_lshl_add_u32 v234, v222, 4, v234
    s_waitcnt vmcnt(14) lgkmcnt(3)
    v_mfma_f32_32x32x16_bf16 v[0:15], a[128:131], v[112:115], v[0:15]
    ds_read_b64_tr_b16 a[136:137], v204 offset:2048
    ds_read_b64_tr_b16 a[138:139], v204 offset:3072
    ds_read_b64_tr_b16 a[140:141], v205 offset:2048
    ds_read_b64_tr_b16 a[142:143], v205 offset:3072
    s_waitcnt lgkmcnt(5)
    v_mfma_f32_32x32x16_bf16 v[16:31], a[132:135], v[112:115], v[16:31]
    buffer_load_dwordx4 v[104:107], v218, s[48:51], s89 offen offset:1024 sc1
    s_waitcnt vmcnt(14)
    v_mfma_f32_32x32x16_bf16 v[32:47], a[128:131], v[116:119], v[32:47]
    buffer_load_dwordx4 v[108:111], v219, s[48:51], s89 offen offset:1024 sc1
    v_mfma_f32_32x32x16_bf16 v[48:63], a[132:135], v[116:119], v[48:63]
    ds_write_b128 v230, v[246:249] offset:50176
    v_lshlrev_b32 v231, 4, v221
    v_lshl_add_u32 v231, v210, 4, v231
    v_lshl_add_u32 v231, v222, 3, v231
    s_waitcnt vmcnt(14) lgkmcnt(3)
    v_mfma_f32_32x32x16_bf16 v[0:15], a[136:139], v[120:123], v[0:15]
    s_waitcnt lgkmcnt(1)
    v_mfma_f32_32x32x16_bf16 v[16:31], a[140:143], v[120:123], v[16:31]
    buffer_load_dwordx4 v[112:115], v218, s[48:51], s89 offen offset:2048 sc1
    s_waitcnt vmcnt(14)
    v_mfma_f32_32x32x16_bf16 v[32:47], a[136:139], v[124:127], v[32:47]
    buffer_load_dwordx4 v[116:119], v219, s[48:51], s89 offen offset:2048 sc1
    v_mfma_f32_32x32x16_bf16 v[48:63], a[140:143], v[124:127], v[48:63]
    s_waitcnt vmcnt(14)
    v_mfma_f32_32x32x16_bf16 v[0:15], a[0:3], v[128:131], v[0:15]
    v_add_u32 v236, s13, v231
    v_xor_b32 v237, 16, v236
    v_xor_b32_e64 v238, 32, v236
    v_xor_b32 v239, 48, v236
    v_mul_u32_u24 v235, 16640, v222
    v_mfma_f32_32x32x16_bf16 v[16:31], a[4:7], v[128:131], v[16:31]
    buffer_load_dwordx4 v[120:123], v218, s[48:51], s89 offen offset:3072 sc1
    s_waitcnt vmcnt(14)
    v_mfma_f32_32x32x16_bf16 v[32:47], a[0:3], v[132:135], v[32:47]
    buffer_load_dwordx4 v[124:127], v219, s[48:51], s89 offen offset:3072 sc1
    s_add_u32 s89, s89, 4096
    v_mfma_f32_32x32x16_bf16 v[48:63], a[4:7], v[132:135], v[48:63]
    v_add_u32_e64 v235, v235, v210
    ds_read_b64 v[64:65], v236 offset:49152
    ds_read_b64 v[66:67], v237 offset:49152
    ds_read_b64 v[68:69], v238 offset:49152
    ds_read_b64 v[70:71], v239 offset:49152
    s_waitcnt vmcnt(14)
    v_mfma_f32_32x32x16_bf16 v[0:15], a[8:11], v[136:139], v[0:15]
    s_mul_i32 s74, s17, 2080
    s_lshl_b32 s75, s97, 2
    v_mfma_f32_32x32x16_bf16 v[16:31], a[12:15], v[136:139], v[16:31]
    buffer_load_dwordx4 v[128:131], v218, s[48:51], s89 offen offset:0 sc1
    s_waitcnt vmcnt(14)
    v_mfma_f32_32x32x16_bf16 v[32:47], a[8:11], v[140:143], v[32:47]
    buffer_load_dwordx4 v[132:135], v219, s[48:51], s89 offen offset:0 sc1
    v_mfma_f32_32x32x16_bf16 v[48:63], a[12:15], v[140:143], v[48:63]
    s_add_u32 s74, s74, s75
    s_add_u32 s96, s74, 9437184
    s_waitcnt vmcnt(13)
    v_mfma_f32_32x32x16_bf16 v[0:15], a[16:19], v[144:147], v[0:15]
    v_xor_b32 v241, 4096, v230
    v_mfma_f32_32x32x16_bf16 v[16:31], a[20:23], v[144:147], v[16:31]
    buffer_load_dwordx4 v[136:139], v218, s[48:51], s89 offen offset:1024 sc1
    s_waitcnt vmcnt(13)
    v_mfma_f32_32x32x16_bf16 v[32:47], a[16:19], v[148:151], v[32:47]
    buffer_load_dwordx4 v[140:143], v219, s[48:51], s89 offen offset:1024 sc1
    v_mfma_f32_32x32x16_bf16 v[48:63], a[20:23], v[148:151], v[48:63]
    v_xor_b32 v242, 8192, v230
    v_xor_b32 v243, 12288, v230
    s_waitcnt vmcnt(13)
    v_mfma_f32_32x32x16_bf16 v[0:15], a[24:27], v[152:155], v[0:15]
    v_mfma_f32_32x32x16_bf16 v[16:31], a[28:31], v[152:155], v[16:31]
    buffer_load_dwordx4 v[144:147], v218, s[48:51], s89 offen offset:2048 sc1
    s_waitcnt vmcnt(13)
    v_mfma_f32_32x32x16_bf16 v[32:47], a[24:27], v[156:159], v[32:47]
    buffer_load_dwordx4 v[148:151], v219, s[48:51], s89 offen offset:2048 sc1
    v_mfma_f32_32x32x16_bf16 v[48:63], a[28:31], v[156:159], v[48:63]
    s_waitcnt vmcnt(13)
    v_mfma_f32_32x32x16_bf16 v[0:15], a[32:35], v[96:99], v[0:15]
    v_mfma_f32_32x32x16_bf16 v[16:31], a[36:39], v[96:99], v[16:31]
    buffer_load_dwordx4 v[152:155], v218, s[48:51], s89 offen offset:3072 sc1
    s_waitcnt vmcnt(13)
    v_mfma_f32_32x32x16_bf16 v[32:47], a[32:35], v[100:103], v[32:47]
    buffer_load_dwordx4 v[156:159], v219, s[48:51], s89 offen offset:3072 sc1
    s_add_u32 s89, s89, 4096
    v_mfma_f32_32x32x16_bf16 v[48:63], a[36:39], v[100:103], v[48:63]
    s_waitcnt vmcnt(13)
    v_mfma_f32_32x32x16_bf16 v[0:15], a[40:43], v[104:107], v[0:15]
    s_waitcnt lgkmcnt(3)
    v_lshlrev_b32_e64 v80, 16, v64
    v_and_b32 v81, s78, v64
    v_mfma_f32_32x32x16_bf16 v[16:31], a[44:47], v[104:107], v[16:31]
    buffer_load_dwordx4 v[96:99], v218, s[48:51], s89 offen offset:0 sc1
    s_waitcnt vmcnt(13)
    v_mfma_f32_32x32x16_bf16 v[32:47], a[40:43], v[108:111], v[32:47]
    buffer_load_dwordx4 v[100:103], v219, s[48:51], s89 offen offset:0 sc1
    v_mfma_f32_32x32x16_bf16 v[48:63], a[44:47], v[108:111], v[48:63]
    v_lshlrev_b32_e64 v82, 16, v65
    v_and_b32 v83, s78, v65
    s_waitcnt vmcnt(13)
    v_mfma_f32_32x32x16_bf16 v[0:15], a[48:51], v[112:115], v[0:15]
    s_waitcnt lgkmcnt(2)
    v_lshlrev_b32 v84, 16, v66
    v_and_b32 v85, s78, v66
    v_mfma_f32_32x32x16_bf16 v[16:31], a[52:55], v[112:115], v[16:31]
    buffer_load_dwordx4 v[104:107], v218, s[48:51], s89 offen offset:1024 sc1
    s_waitcnt vmcnt(13)
    v_mfma_f32_32x32x16_bf16 v[32:47], a[48:51], v[116:119], v[32:47]
    buffer_load_dwordx4 v[108:111], v219, s[48:51], s89 offen offset:1024 sc1
    v_mfma_f32_32x32x16_bf16 v[48:63], a[52:55], v[116:119], v[48:63]
    v_lshlrev_b32_e64 v86, 16, v67
    v_and_b32 v87, s78, v67
    s_waitcnt vmcnt(13)
    v_mfma_f32_32x32x16_bf16 v[0:15], a[56:59], v[120:123], v[0:15]
    buffer_load_dword v213, v210, s[48:51], s80 offen sc1
    v_mfma_f32_32x32x16_bf16 v[16:31], a[60:63], v[120:123], v[16:31]
    buffer_load_dwordx4 v[112:115], v218, s[48:51], s89 offen offset:2048 sc1
    s_waitcnt vmcnt(14)
    v_mfma_f32_32x32x16_bf16 v[32:47], a[56:59], v[124:127], v[32:47]
    buffer_load_dwordx4 v[116:119], v219, s[48:51], s89 offen offset:2048 sc1
    v_mfma_f32_32x32x16_bf16 v[48:63], a[60:63], v[124:127], v[48:63]
    s_waitcnt lgkmcnt(1)
    v_lshlrev_b32 v88, 16, v68
    v_and_b32 v89, s78, v68
    v_lshlrev_b32 v90, 16, v69
    v_and_b32 v91, s78, v69
    s_waitcnt vmcnt(14)
    v_mfma_f32_32x32x16_bf16 v[16:31], a[68:71], v[128:131], v[16:31]
    buffer_load_dwordx4 v[120:123], v218, s[48:51], s89 offen offset:3072 sc1
    s_waitcnt vmcnt(14)
    v_mfma_f32_32x32x16_bf16 v[32:47], a[64:67], v[132:135], v[32:47]
    buffer_load_dwordx4 v[124:127], v219, s[48:51], s89 offen offset:3072 sc1
    s_add_u32 s89, s89, 4096
    v_mfma_f32_32x32x16_bf16 v[48:63], a[68:71], v[132:135], v[48:63]
    s_waitcnt lgkmcnt(0)
    v_lshlrev_b32 v92, 16, v70
    v_and_b32 v93, s78, v70
    v_lshlrev_b32 v94, 16, v71
    v_and_b32_e64 v95, s78, v71
    s_waitcnt vmcnt(14)
    v_mfma_f32_32x32x16_bf16 v[16:31], a[76:79], v[136:139], v[16:31]
    s_waitcnt vmcnt(13)
    v_mfma_f32_32x32x16_bf16 v[32:47], a[72:75], v[140:143], v[32:47]
    v_mfma_f32_32x32x16_bf16 v[48:63], a[76:79], v[140:143], v[48:63]
    s_waitcnt vmcnt(12)
    v_mfma_f32_32x32x16_bf16 v[16:31], a[84:87], v[144:147], v[16:31]
    s_waitcnt vmcnt(11)
    v_mfma_f32_32x32x16_bf16 v[32:47], a[80:83], v[148:151], v[32:47]
    v_mfma_f32_32x32x16_bf16 v[48:63], a[84:87], v[148:151], v[48:63]
    s_waitcnt vmcnt(10)
    v_mfma_f32_32x32x16_bf16 v[16:31], a[92:95], v[152:155], v[16:31]
    s_waitcnt vmcnt(9)
    v_mfma_f32_32x32x16_bf16 v[32:47], a[88:91], v[156:159], v[32:47]
    v_mfma_f32_32x32x16_bf16 v[48:63], a[92:95], v[156:159], v[48:63]
    s_waitcnt vmcnt(4)
    v_cmp_ne_u32_e64 vcc, s64, v213
    s_cbranch_vccnz L_slow_fy
L_back_fy:
    v_mfma_f32_32x32x16_bf16 v[16:31], a[100:103], v[96:99], v[16:31]
    buffer_load_dword v72, v235, s[48:51], s96 offen sc1
    s_add_u32 s96, s96, 8320
    v_mfma_f32_32x32x16_bf16 v[32:47], a[96:99], v[100:103], v[32:47]
    buffer_load_dword v73, v235, s[48:51], s96 offen sc1
    s_add_u32 s96, s96, 24960
    v_mfma_f32_32x32x16_bf16 v[48:63], a[100:103], v[100:103], v[48:63]
    buffer_load_dword v74, v235, s[48:51], s96 offen sc1
    s_add_u32 s96, s96, 8320
    buffer_load_dword v75, v235, s[48:51], s96 offen sc1
    s_add_u32 s96, s96, 24960
    v_mfma_f32_32x32x16_bf16 v[16:31], a[108:111], v[104:107], v[16:31]
    buffer_load_dword v76, v235, s[48:51], s96 offen sc1
    s_add_u32 s96, s96, 8320
    v_mfma_f32_32x32x16_bf16 v[32:47], a[104:107], v[108:111], v[32:47]
    buffer_load_dword v77, v235, s[48:51], s96 offen sc1
    s_add_u32 s96, s96, 24960
    v_mfma_f32_32x32x16_bf16 v[48:63], a[108:111], v[108:111], v[48:63]
    buffer_load_dword v78, v235, s[48:51], s96 offen sc1
    s_add_u32 s96, s96, 8320
    buffer_load_dword v79, v235, s[48:51], s96 offen sc1
    s_add_u32 s96, s96, 24960
    s_waitcnt vmcnt(11)
    v_mfma_f32_32x32x16_bf16 v[16:31], a[116:119], v[112:115], v[16:31]
    s_waitcnt vmcnt(10)
    v_mfma_f32_32x32x16_bf16 v[32:47], a[112:115], v[116:119], v[32:47]
    v_mfma_f32_32x32x16_bf16 v[48:63], a[116:119], v[116:119], v[48:63]
    s_waitcnt vmcnt(9)
    v_mfma_f32_32x32x16_bf16 v[16:31], a[124:127], v[120:123], v[16:31]
    s_waitcnt vmcnt(8)
    v_mfma_f32_32x32x16_bf16 v[32:47], a[120:123], v[124:127], v[32:47]
    v_mfma_f32_32x32x16_bf16 v[48:63], a[124:127], v[124:127], v[48:63]
    v_mfma_f32_32x32x16_bf16 v[0:15], a[64:67], v[128:131], v[0:15]
    s_nop 7
    ds_write_b128 v230, v[16:19] offset:0
    v_mfma_f32_32x32x16_bf16 v[0:15], a[72:75], v[136:139], v[0:15]
    ds_write_b128 v230, v[32:35] offset:16384
    v_mfma_f32_32x32x16_bf16 v[0:15], a[80:83], v[144:147], v[0:15]
    ds_write_b128 v230, v[48:51] offset:32768
    v_mfma_f32_32x32x16_bf16 v[0:15], a[88:91], v[152:155], v[0:15]
    v_mfma_f32_32x32x16_bf16 v[0:15], a[96:99], v[96:99], v[0:15]
    ds_write_b128 v230, v[20:23] offset:1024
    v_mfma_f32_32x32x16_bf16 v[0:15], a[104:107], v[104:107], v[0:15]
    ds_write_b128 v230, v[36:39] offset:17408
    v_mfma_f32_32x32x16_bf16 v[0:15], a[112:115], v[112:115], v[0:15]
    ds_write_b128 v230, v[52:55] offset:33792
    v_mfma_f32_32x32x16_bf16 v[0:15], a[120:123], v[120:123], v[0:15]
    s_waitcnt vmcnt(7)
    v_lshlrev_b32 v64, 16, v72
    v_and_b32 v65, s78, v72
    v_add_f32 v80, v80, v64
    v_add_f32 v81, v81, v65
    s_waitcnt vmcnt(6)
    v_lshlrev_b32 v64, 16, v73
    v_and_b32 v65, s78, v73
    v_add_f32 v82, v82, v64
    v_add_f32 v83, v83, v65
    s_waitcnt vmcnt(5)
    v_lshlrev_b32 v64, 16, v74
    v_and_b32 v65, s78, v74
    v_add_f32 v84, v84, v64
    v_add_f32 v85, v85, v65
    s_waitcnt vmcnt(4)
    v_lshlrev_b32 v64, 16, v75
    v_and_b32 v65, s78, v75
    v_add_f32 v86, v86, v64
    v_add_f32_e64 v87, v87, v65
    s_waitcnt lgkmcnt(0)
    s_barrier
    ds_read_b128 v[16:19], v241 offset:0
    ds_read_b128 v[32:35], v242 offset:16384
    ds_read_b128 v[48:51], v243 offset:32768
    ds_read_b128 v[20:23], v241 offset:1024
    ds_read_b128 v[36:39], v242 offset:17408
    ds_read_b128 v[52:55], v243 offset:33792
    ds_write_b128 v230, v[24:27] offset:2048
    s_waitcnt vmcnt(3)
    v_lshlrev_b32 v64, 16, v76
    v_and_b32 v65, s78, v76
    v_add_f32 v88, v88, v64
    v_add_f32 v89, v89, v65
    s_waitcnt vmcnt(2)
    v_lshlrev_b32_e64 v64, 16, v77
    ds_write_b128 v230, v[40:43] offset:18432
    v_and_b32 v65, s78, v77
    v_add_f32 v90, v90, v64
    v_add_f32 v91, v91, v65
    s_waitcnt vmcnt(1)
    v_lshlrev_b32_e64 v64, 16, v78
    ds_write_b128 v230, v[56:59] offset:34816
    v_and_b32 v65, s78, v78
    v_add_f32 v92, v92, v64
    v_add_f32 v93, v93, v65
    s_waitcnt vmcnt(0)
    v_lshlrev_b32_e64 v64, 16, v79
    ds_write_b128 v230, v[28:31] offset:3072
    v_and_b32 v65, s78, v79
    v_add_f32 v94, v94, v64
    v_add_f32 v95, v95, v65
    s_waitcnt lgkmcnt(9)
    v_pk_add_f32 v[0:1], v[0:1], v[16:17]
    s_waitcnt lgkmcnt(8)
    v_pk_add_f32 v[0:1], v[0:1], v[32:33]
    ds_write_b128 v230, v[44:47] offset:19456
    s_waitcnt lgkmcnt(8)
    v_pk_add_f32 v[0:1], v[0:1], v[48:49]
    v_pk_fma_f32 v[0:1], v[0:1], v[228:229], v[80:81] op_sel_hi:[1,0,1]
    v_pk_add_f32 v[2:3], v[2:3], v[18:19]
    v_pk_add_f32 v[2:3], v[2:3], v[34:35]
    ds_write_b128 v230, v[60:63] offset:35840
    v_pk_add_f32 v[2:3], v[2:3], v[50:51]
    v_pk_fma_f32 v[2:3], v[2:3], v[228:229], v[82:83] op_sel_hi:[1,0,1]
    v_cvt_pk_bf16_f32 v116, v0, v1
    v_cvt_pk_bf16_f32 v117, v2, v3
    s_waitcnt lgkmcnt(8)
    v_pk_add_f32 v[4:5], v[4:5], v[20:21]
    s_waitcnt lgkmcnt(7)
    v_pk_add_f32 v[4:5], v[4:5], v[36:37]
    s_waitcnt lgkmcnt(6)
    v_pk_add_f32 v[4:5], v[4:5], v[52:53]
    v_pk_fma_f32 v[4:5], v[4:5], v[228:229], v[84:85] op_sel_hi:[1,0,1]
    v_pk_add_f32 v[6:7], v[6:7], v[22:23]
    v_pk_add_f32 v[6:7], v[6:7], v[38:39]
    v_pk_add_f32 v[6:7], v[6:7], v[54:55]
    v_pk_fma_f32 v[6:7], v[6:7], v[228:229], v[86:87] op_sel_hi:[1,0,1]
    v_cvt_pk_bf16_f32 v118, v4, v5
    v_cvt_pk_bf16_f32 v119, v6, v7
    s_nop 0
    v_permlane32_swap_b32 v116, v118
    v_permlane32_swap_b32 v117, v119
    buffer_store_dwordx4 v[116:119], v234, s[52:55], s16 offen offset:0
    s_waitcnt lgkmcnt(0)
    s_barrier
    ds_read_b128 v[24:27], v241 offset:2048
    ds_read_b128 v[40:43], v242 offset:18432
    ds_read_b128 v[56:59], v243 offset:34816
    ds_read_b128 v[28:31], v241 offset:3072
    ds_read_b128 v[44:47], v242 offset:19456
    ds_read_b128 v[60:63], v243 offset:35840
    s_waitcnt lgkmcnt(5)
    v_pk_add_f32 v[8:9], v[8:9], v[24:25]
    s_waitcnt lgkmcnt(4)
    v_pk_add_f32 v[8:9], v[8:9], v[40:41]
    s_waitcnt lgkmcnt(3)
    v_pk_add_f32 v[8:9], v[8:9], v[56:57]
    v_pk_fma_f32 v[8:9], v[8:9], v[228:229], v[88:89] op_sel_hi:[1,0,1]
    v_pk_add_f32 v[10:11], v[10:11], v[26:27]
    v_pk_add_f32 v[10:11], v[10:11], v[42:43]
    v_pk_add_f32 v[10:11], v[10:11], v[58:59]
    v_pk_fma_f32 v[10:11], v[10:11], v[228:229], v[90:91] op_sel_hi:[1,0,1]
    v_cvt_pk_bf16_f32 v120, v8, v9
    v_cvt_pk_bf16_f32 v121, v10, v11
    s_waitcnt lgkmcnt(2)
    v_pk_add_f32 v[12:13], v[12:13], v[28:29]
    s_waitcnt lgkmcnt(1)
    v_pk_add_f32 v[12:13], v[12:13], v[44:45]
    s_waitcnt lgkmcnt(0)
    v_pk_add_f32 v[12:13], v[12:13], v[60:61]
    v_pk_fma_f32 v[12:13], v[12:13], v[228:229], v[92:93] op_sel_hi:[1,0,1]
    v_pk_add_f32 v[14:15], v[14:15], v[30:31]
    v_pk_add_f32 v[14:15], v[14:15], v[46:47]
    v_pk_add_f32 v[14:15], v[14:15], v[62:63]
    v_pk_fma_f32 v[14:15], v[14:15], v[228:229], v[94:95] op_sel_hi:[1,0,1]
    v_cvt_pk_bf16_f32 v122, v12, v13
    v_cvt_pk_bf16_f32 v123, v14, v15
    s_nop 0
    v_permlane32_swap_b32 v120, v122
    v_permlane32_swap_b32_e64 v121, v123
    buffer_store_dwordx4 v[120:123], v234, s[52:55], s16 offen offset:32
    s_endpgm
L_helper:
    s_lshl_b32 s59, s57, 2
    s_add_u32 s59, s59, s58
    v_mov_b32 v203, 0
    v_lshrrev_b32 v1, 2, v255
    s_lshl_b32 s83, s59, 2
    s_add_u32 s83, s83, s56
    s_lshl_b32 s72, s83, 4
    v_add_u32_e64 v4, s72, v1
    v_mul_u32_u24 v5, 896, v4
    v_and_b32_e64 v2, 3, v255
    v_lshl_add_u32 v5, v2, 4, v5
    s_lshr_b32 s73, s57, 1
    s_lshl_b32 s73, s73, 2
    s_add_u32 s60, s73, s58
    s_min_u32 s73, s60, 13
    s_and_b32 s74, s57, 1
    s_mul_i32 s74, s74, 14
    s_add_u32 s61, s73, s74
    s_lshr_b32 s73, s61, 1
    s_lshl_b32 s82, s73, 8
    v_lshrrev_b32 v6, 4, v255
    s_lshl_b32 s75, s56, 2
    v_add_u32 v6, s75, v6
    v_mul_u32_u24 v7, 3584, v6
    v_and_b32 v3, 15, v255
    v_lshl_add_u32 v7, v3, 4, v7
    s_mov_b32 s72, 11714560
    s_waitcnt lgkmcnt(0)
    s_mov_b32 s36, s4
    s_mov_b32 s37, s5
    s_add_u32 s48, s34, 0
    s_addc_u32 s49, s35, 0
    buffer_load_dword v202, v203, s[48:51], s72 offen sc1
    buffer_load_dwordx4 v[8:11], v5, s[36:39], 0 offen offset:0
    buffer_load_dwordx4 v[12:15], v5, s[36:39], 0 offen offset:64
    buffer_load_dwordx4 v[16:19], v5, s[36:39], 0 offen offset:128
    buffer_load_dwordx4 v[20:23], v5, s[36:39], 0 offen offset:192
    buffer_load_dwordx4 v[24:27], v5, s[36:39], 0 offen offset:256
    buffer_load_dwordx4 v[28:31], v5, s[36:39], 0 offen offset:320
    buffer_load_dwordx4 v[32:35], v5, s[36:39], 0 offen offset:384
    buffer_load_dwordx4 v[36:39], v5, s[36:39], 0 offen offset:448
    buffer_load_dwordx4 v[40:43], v5, s[36:39], 0 offen offset:512
    buffer_load_dwordx4 v[44:47], v5, s[36:39], 0 offen offset:576
    buffer_load_dwordx4 v[48:51], v5, s[36:39], 0 offen offset:640
    buffer_load_dwordx4 v[52:55], v5, s[36:39], 0 offen offset:704
    buffer_load_dwordx4 v[56:59], v5, s[36:39], 0 offen offset:768
    buffer_load_dwordx4 v[60:63], v5, s[36:39], 0 offen offset:832
    s_mov_b32 s73, 1664525
    s_waitcnt vmcnt(14)
    v_mul_lo_u32 v202, v202, s73
    s_cmp_eq_u32 s83, 127
    v_add_u32 v202, 1013904225, v202
    v_or_b32 v202, 1, v202
    s_cbranch_scc0 L_hnoep
    s_mov_b64 exec, 1
    global_store_dword v203, v202, s[32:33] sc1
    buffer_store_dword v202, v203, s[48:51], s72 offen sc1
    s_mov_b64 exec, -1
L_hnoep:
    s_bitcmp1_b32 s61, 0
    s_cselect_b32 s40, s26, s24
    s_cselect_b32 s41, s27, s25
    s_mov_b32 s76, 0x3f803f80
    s_mov_b32 s77, 0x00003f80
    s_mov_b32 s79, 0x3f800000
    s_waitcnt vmcnt(13)
    v_dot2_f32_bf16 v64, v8, s76, 0
    v_dot2_f32_bf16 v68, v8, v8, 0
    v_dot2_f32_bf16 v64, v9, s76, v64
    v_dot2_f32_bf16 v68, v9, v9, v68
    v_dot2_f32_bf16 v64, v10, s76, v64
    v_dot2_f32_bf16 v68, v10, v10, v68
    v_dot2_f32_bf16 v64, v11, s76, v64
    v_dot2_f32_bf16 v68, v11, v11, v68
    s_waitcnt vmcnt(12)
    v_dot2_f32_bf16 v64, v12, s76, v64
    v_dot2_f32_bf16 v68, v12, v12, v68
    v_dot2_f32_bf16 v64, v13, s76, v64
    v_dot2_f32_bf16 v68, v13, v13, v68
    v_dot2_f32_bf16 v64, v14, s76, v64
    v_dot2_f32_bf16 v68, v14, v14, v68
    v_dot2_f32_bf16 v64, v15, s76, v64
    v_dot2_f32_bf16 v68, v15, v15, v68
    s_waitcnt vmcnt(11)
    v_dot2_f32_bf16 v64, v16, s76, v64
    v_dot2_f32_bf16 v68, v16, v16, v68
    v_dot2_f32_bf16 v64, v17, s76, v64
    v_dot2_f32_bf16 v68, v17, v17, v68
    v_dot2_f32_bf16 v64, v18, s76, v64
    v_dot2_f32_bf16 v68, v18, v18, v68
    v_dot2_f32_bf16 v64, v19, s76, v64
    v_dot2_f32_bf16 v68, v19, v19, v68
    s_waitcnt vmcnt(10)
    v_dot2_f32_bf16 v64, v20, s76, v64
    v_dot2_f32_bf16 v68, v20, v20, v68
    v_dot2_f32_bf16 v64, v21, s76, v64
    v_dot2_f32_bf16 v68, v21, v21, v68
    v_dot2_f32_bf16 v64, v22, s76, v64
    v_dot2_f32_bf16 v68, v22, v22, v68
    v_dot2_f32_bf16 v64, v23, s76, v64
    v_dot2_f32_bf16 v68, v23, v23, v68
    s_waitcnt vmcnt(9)
    v_dot2_f32_bf16 v64, v24, s76, v64
    v_dot2_f32_bf16 v68, v24, v24, v68
    v_dot2_f32_bf16 v64, v25, s76, v64
    v_dot2_f32_bf16 v68, v25, v25, v68
    v_dot2_f32_bf16 v64, v26, s76, v64
    v_dot2_f32_bf16 v68, v26, v26, v68
    v_dot2_f32_bf16 v64, v27, s76, v64
    v_dot2_f32_bf16 v68, v27, v27, v68
    s_waitcnt vmcnt(8)
    v_dot2_f32_bf16 v64, v28, s76, v64
    v_dot2_f32_bf16 v68, v28, v28, v68
    v_dot2_f32_bf16 v64, v29, s76, v64
    v_dot2_f32_bf16 v68, v29, v29, v68
    v_dot2_f32_bf16 v64, v30, s76, v64
    v_dot2_f32_bf16 v68, v30, v30, v68
    v_dot2_f32_bf16 v64, v31, s76, v64
    v_dot2_f32_bf16 v68, v31, v31, v68
    s_waitcnt vmcnt(7)
    v_dot2_f32_bf16 v64, v32, s76, v64
    v_dot2_f32_bf16 v68, v32, v32, v68
    v_dot2_f32_bf16 v64, v33, s76, v64
    v_dot2_f32_bf16 v68, v33, v33, v68
    v_dot2_f32_bf16 v64, v34, s76, v64
    v_dot2_f32_bf16 v68, v34, v34, v68
    v_dot2_f32_bf16 v64, v35, s76, v64
    v_dot2_f32_bf16 v68, v35, v35, v68
    s_waitcnt vmcnt(6)
    v_dot2_f32_bf16 v64, v36, s76, v64
    v_dot2_f32_bf16 v68, v36, v36, v68
    v_dot2_f32_bf16 v64, v37, s76, v64
    v_dot2_f32_bf16 v68, v37, v37, v68
    v_dot2_f32_bf16 v64, v38, s76, v64
    v_dot2_f32_bf16 v68, v38, v38, v68
    v_dot2_f32_bf16 v64, v39, s76, v64
    v_dot2_f32_bf16 v68, v39, v39, v68
    s_waitcnt vmcnt(5)
    v_dot2_f32_bf16 v64, v40, s76, v64
    v_dot2_f32_bf16 v68, v40, v40, v68
    v_dot2_f32_bf16 v64, v41, s76, v64
    v_dot2_f32_bf16 v68, v41, v41, v68
    v_dot2_f32_bf16 v64, v42, s76, v64
    v_dot2_f32_bf16 v68, v42, v42, v68
    v_dot2_f32_bf16 v64, v43, s76, v64
    v_dot2_f32_bf16 v68, v43, v43, v68
    s_waitcnt vmcnt(4)
    v_dot2_f32_bf16 v64, v44, s76, v64
    v_dot2_f32_bf16 v68, v44, v44, v68
    v_dot2_f32_bf16 v64, v45, s76, v64
    v_dot2_f32_bf16 v68, v45, v45, v68
    v_dot2_f32_bf16 v64, v46, s76, v64
    v_dot2_f32_bf16 v68, v46, v46, v68
    v_dot2_f32_bf16 v64, v47, s76, v64
    v_dot2_f32_bf16 v68, v47, v47, v68
    s_waitcnt vmcnt(3)
    v_dot2_f32_bf16 v64, v48, s76, v64
    v_dot2_f32_bf16 v68, v48, v48, v68
    v_dot2_f32_bf16 v64, v49, s76, v64
    v_dot2_f32_bf16 v68, v49, v49, v68
    v_dot2_f32_bf16 v64, v50, s76, v64
    v_dot2_f32_bf16 v68, v50, v50, v68
    v_dot2_f32_bf16 v64, v51, s76, v64
    v_dot2_f32_bf16 v68, v51, v51, v68
    s_waitcnt vmcnt(2)
    v_dot2_f32_bf16 v64, v52, s76, v64
    v_dot2_f32_bf16 v68, v52, v52, v68
    v_dot2_f32_bf16 v64, v53, s76, v64
    v_dot2_f32_bf16 v68, v53, v53, v68
    v_dot2_f32_bf16 v64, v54, s76, v64
    v_dot2_f32_bf16 v68, v54, v54, v68
    v_dot2_f32_bf16 v64, v55, s76, v64
    v_dot2_f32_bf16 v68, v55, v55, v68
    s_waitcnt vmcnt(1)
    v_dot2_f32_bf16 v64, v56, s76, v64
    v_dot2_f32_bf16 v68, v56, v56, v68
    v_dot2_f32_bf16 v64, v57, s76, v64
    v_dot2_f32_bf16 v68, v57, v57, v68
    v_dot2_f32_bf16 v64, v58, s76, v64
    v_dot2_f32_bf16 v68, v58, v58, v68
    v_dot2_f32_bf16 v64, v59, s76, v64
    v_dot2_f32_bf16 v68, v59, v59, v68
    s_waitcnt vmcnt(0)
    v_dot2_f32_bf16 v64, v60, s76, v64
    v_dot2_f32_bf16 v68, v60, v60, v68
    v_dot2_f32_bf16 v64, v61, s76, v64
    v_dot2_f32_bf16 v68, v61, v61, v68
    v_dot2_f32_bf16 v64, v62, s76, v64
    v_dot2_f32_bf16 v68, v62, v62, v68
    v_dot2_f32_bf16 v64, v63, s76, v64
    v_dot2_f32_bf16 v68, v63, v63, v68
    s_nop 1
    v_add_f32_dpp v64, v64, v64 quad_perm:[1,0,3,2] row_mask:0xf bank_mask:0xf
    v_add_f32_dpp v68, v68, v68 quad_perm:[1,0,3,2] row_mask:0xf bank_mask:0xf
    v_lshlrev_b32_e64 v4, 3, v4
    v_add_f32_dpp v64, v64, v64 quad_perm:[2,3,0,1] row_mask:0xf bank_mask:0xf
    v_add_f32_dpp v68, v68, v68 quad_perm:[2,3,0,1] row_mask:0xf bank_mask:0xf
    v_mul_f32 v64, 0x3b124925, v64
    v_mul_f32 v68, 0x3b124925, v68
    v_fma_f32 v68, -v64, v64, v68
    v_cvt_pk_bf16_f32 v64, -v64, -v64
    v_max_f32_e64 v68, 0, v68
    v_cvt_pk_bf16_f32 v68, v68, v68
    v_and_b32_e64 v68, s78, v68
    v_add_f32 v68, 0x3727c5ac, v68
    v_cvt_pk_bf16_f32 v68, v68, v68
    v_and_b32 v68, s78, v68
    v_sqrt_f32 v68, v68
    v_and_b32_e64 v66, s78, v64
    v_cvt_pk_bf16_f32 v68, v68, v68
    v_and_b32 v68, s78, v68
    v_rcp_f32 v70, v68
    s_mov_b32 s74, 11534336
    v_fma_f32 v71, -v68, v70, 1.0
    v_fma_f32 v70, v70, v71, v70
    v_mul_f32 v65, v70, v70
    v_mul_f32 v71, v66, v70
    s_mov_b32 s80, 0x11111111
    s_mov_b32 s81, 0x11111111
    s_mov_b64 exec, s[80:81]
    buffer_store_dwordx2 v[64:65], v4, s[48:51], s74 offen sc1
    s_mov_b64 exec, -1
    v_mul_u32_u24 v5, 960, v1
    s_mul_i32 s75, s56, 15360
    v_lshl_add_u32 v5, v2, 4, v5
    v_add_u32 v5, s75, v5
    v_lshrrev_b32 v1, 5, v255
    v_bfe_u32 v2, v255, 2, 2
    v_lshl_add_u32 v2, v1, 3, v2
    v_mul_u32_u24 v2, 960, v2
    v_bfe_u32 v4, v255, 4, 1
    v_lshl_add_u32 v2, v4, 5, v2
    v_and_b32_e64 v4, 3, v255
    v_lshl_add_u32 v2, v4, 3, v2
    v_add_u32_e64 v194, s75, v2
    v_and_b32 v4, 31, v255
    v_mul_u32_u24 v4, 144, v4
    s_lshl_b32 s74, s56, 5
    s_add_u32 s74, s74, 61440
    v_lshl_add_u32 v4, v1, 4, v4
    v_add_u32 v195, s74, v4
    v_lshlrev_b32 v6, 9, v6
    v_lshl_add_u32 v6, v3, 5, v6
    v_add_u32 v6, 125952, v6
    v_lshrrev_b32 v1, 3, v255
    v_and_b32 v2, 7, v255
    v_lshlrev_b32_e64 v2, 4, v2
    v_mul_u32_u24 v197, 4224, v1
    v_add_u32_e64 v197, v197, v2
    v_mul_u32_u24 v1, 144, v1
    v_add_u32_e64 v1, v1, v2
    s_mul_i32 s74, s56, 16128
    s_add_u32 s74, s74, 61440
    v_add_u32_e64 v196, s74, v1
    s_lshl_b32 s74, s59, 7
    s_mul_i32 s75, s56, 473088
    s_add_u32 s74, s74, s75
    s_add_u32 s62, s74, 7340032
    s_and_b32 s75, s56, 1
    s_lshl_b32 s75, s75, 8
    v_lshl_add_u32 v2, v255, 2, s75
    v_add_u32 v198, 125952, v2
    v_dot2_f32_bf16 v186, v8, s77, v66
    v_dot2_f32_bf16 v187, v8, s79, v66
    buffer_load_dwordx4 v[72:75], v7, s[40:43], s82 offen
    s_add_u32 s82, s82, 57344
    v_dot2_f32_bf16 v188, v9, s77, v66
    v_dot2_f32_bf16 v189, v9, s79, v66
    v_cvt_pk_bf16_f32 v8, v186, v187
    v_lshlrev_b32 v186, 16, v8
    v_and_b32 v187, s78, v8
    v_pk_mul_f32 v[186:187], v[186:187], v[70:71] op_sel_hi:[1,0]
    v_cvt_pk_bf16_f32 v8, v186, v187
    v_dot2_f32_bf16 v190, v10, s77, v66
    v_dot2_f32_bf16 v191, v10, s79, v66
    v_cvt_pk_bf16_f32 v9, v188, v189
    v_lshlrev_b32 v188, 16, v9
    v_and_b32 v189, s78, v9
    v_pk_mul_f32 v[188:189], v[188:189], v[70:71] op_sel_hi:[1,0]
    v_cvt_pk_bf16_f32 v9, v188, v189
    v_dot2_f32_bf16 v192, v11, s77, v66
    v_dot2_f32_bf16 v193, v11, s79, v66
    v_cvt_pk_bf16_f32 v10, v190, v191
    v_lshlrev_b32 v190, 16, v10
    v_and_b32 v191, s78, v10
    v_pk_mul_f32 v[190:191], v[190:191], v[70:71] op_sel_hi:[1,0]
    v_cvt_pk_bf16_f32 v10, v190, v191
    v_dot2_f32_bf16 v186, v12, s77, v66
    v_dot2_f32_bf16 v187, v12, s79, v66
    v_cvt_pk_bf16_f32 v11, v192, v193
    v_lshlrev_b32 v192, 16, v11
    v_and_b32 v193, s78, v11
    v_pk_mul_f32 v[192:193], v[192:193], v[70:71] op_sel_hi:[1,0]
    v_cvt_pk_bf16_f32 v11, v192, v193
    ds_write_b128 v5, v[8:11] offset:0
    v_dot2_f32_bf16 v188, v13, s77, v66
    v_dot2_f32_bf16 v189, v13, s79, v66
    v_cvt_pk_bf16_f32 v12, v186, v187
    v_lshlrev_b32 v186, 16, v12
    v_and_b32 v187, s78, v12
    v_pk_mul_f32 v[186:187], v[186:187], v[70:71] op_sel_hi:[1,0]
    v_cvt_pk_bf16_f32 v12, v186, v187
    buffer_load_dwordx4 v[76:79], v7, s[40:43], s82 offen
    s_add_u32 s82, s82, 57344
    v_dot2_f32_bf16 v190, v14, s77, v66
    v_dot2_f32_bf16 v191, v14, s79, v66
    v_cvt_pk_bf16_f32 v13, v188, v189
    v_lshlrev_b32 v188, 16, v13
    v_and_b32 v189, s78, v13
    v_pk_mul_f32 v[188:189], v[188:189], v[70:71] op_sel_hi:[1,0]
    v_cvt_pk_bf16_f32 v13, v188, v189
    v_dot2_f32_bf16 v192, v15, s77, v66
    v_dot2_f32_bf16 v193, v15, s79, v66
    v_cvt_pk_bf16_f32 v14, v190, v191
    v_lshlrev_b32 v190, 16, v14
    v_and_b32 v191, s78, v14
    v_pk_mul_f32 v[190:191], v[190:191], v[70:71] op_sel_hi:[1,0]
    v_cvt_pk_bf16_f32 v14, v190, v191
    v_dot2_f32_bf16 v186, v16, s77, v66
    v_dot2_f32_bf16 v187, v16, s79, v66
    v_cvt_pk_bf16_f32 v15, v192, v193
    v_lshlrev_b32 v192, 16, v15
    v_and_b32 v193, s78, v15
    v_pk_mul_f32 v[192:193], v[192:193], v[70:71] op_sel_hi:[1,0]
    v_cvt_pk_bf16_f32 v15, v192, v193
    ds_write_b128 v5, v[12:15] offset:64
    v_dot2_f32_bf16 v188, v17, s77, v66
    v_dot2_f32_bf16 v189, v17, s79, v66
    v_cvt_pk_bf16_f32 v16, v186, v187
    v_lshlrev_b32 v186, 16, v16
    v_and_b32 v187, s78, v16
    v_pk_mul_f32 v[186:187], v[186:187], v[70:71] op_sel_hi:[1,0]
    v_cvt_pk_bf16_f32 v16, v186, v187
    v_dot2_f32_bf16 v190, v18, s77, v66
    v_dot2_f32_bf16 v191, v18, s79, v66
    v_cvt_pk_bf16_f32 v17, v188, v189
    v_lshlrev_b32 v188, 16, v17
    v_and_b32 v189, s78, v17
    v_pk_mul_f32 v[188:189], v[188:189], v[70:71] op_sel_hi:[1,0]
    v_cvt_pk_bf16_f32 v17, v188, v189
    v_dot2_f32_bf16 v192, v19, s77, v66
    v_dot2_f32_bf16 v193, v19, s79, v66
    v_cvt_pk_bf16_f32 v18, v190, v191
    v_lshlrev_b32 v190, 16, v18
    v_and_b32 v191, s78, v18
    v_pk_mul_f32 v[190:191], v[190:191], v[70:71] op_sel_hi:[1,0]
    v_cvt_pk_bf16_f32 v18, v190, v191
    buffer_load_dwordx4 v[80:83], v7, s[40:43], s82 offen
    s_add_u32 s82, s82, 57344
    v_dot2_f32_bf16 v186, v20, s77, v66
    v_dot2_f32_bf16 v187, v20, s79, v66
    v_cvt_pk_bf16_f32 v19, v192, v193
    v_lshlrev_b32 v192, 16, v19
    v_and_b32 v193, s78, v19
    v_pk_mul_f32 v[192:193], v[192:193], v[70:71] op_sel_hi:[1,0]
    v_cvt_pk_bf16_f32 v19, v192, v193
    ds_write_b128 v5, v[16:19] offset:128
    v_dot2_f32_bf16 v188, v21, s77, v66
    v_dot2_f32_bf16 v189, v21, s79, v66
    v_cvt_pk_bf16_f32 v20, v186, v187
    v_lshlrev_b32 v186, 16, v20
    v_and_b32 v187, s78, v20
    v_pk_mul_f32 v[186:187], v[186:187], v[70:71] op_sel_hi:[1,0]
    v_cvt_pk_bf16_f32 v20, v186, v187
    v_dot2_f32_bf16 v190, v22, s77, v66
    v_dot2_f32_bf16 v191, v22, s79, v66
    v_cvt_pk_bf16_f32 v21, v188, v189
    v_lshlrev_b32 v188, 16, v21
    v_and_b32 v189, s78, v21
    v_pk_mul_f32 v[188:189], v[188:189], v[70:71] op_sel_hi:[1,0]
    v_cvt_pk_bf16_f32 v21, v188, v189
    v_dot2_f32_bf16 v192, v23, s77, v66
    v_dot2_f32_bf16 v193, v23, s79, v66
    v_cvt_pk_bf16_f32 v22, v190, v191
    v_lshlrev_b32 v190, 16, v22
    v_and_b32 v191, s78, v22
    v_pk_mul_f32 v[190:191], v[190:191], v[70:71] op_sel_hi:[1,0]
    v_cvt_pk_bf16_f32 v22, v190, v191
    v_dot2_f32_bf16 v186, v24, s77, v66
    v_dot2_f32_bf16 v187, v24, s79, v66
    v_cvt_pk_bf16_f32 v23, v192, v193
    v_lshlrev_b32 v192, 16, v23
    v_and_b32 v193, s78, v23
    v_pk_mul_f32 v[192:193], v[192:193], v[70:71] op_sel_hi:[1,0]
    v_cvt_pk_bf16_f32 v23, v192, v193
    ds_write_b128 v5, v[20:23] offset:192
    buffer_load_dwordx4 v[84:87], v7, s[40:43], s82 offen
    s_add_u32 s82, s82, 57344
    v_dot2_f32_bf16 v188, v25, s77, v66
    v_dot2_f32_bf16 v189, v25, s79, v66
    v_cvt_pk_bf16_f32 v24, v186, v187
    v_lshlrev_b32 v186, 16, v24
    v_and_b32 v187, s78, v24
    v_pk_mul_f32 v[186:187], v[186:187], v[70:71] op_sel_hi:[1,0]
    v_cvt_pk_bf16_f32 v24, v186, v187
    v_dot2_f32_bf16 v190, v26, s77, v66
    v_dot2_f32_bf16 v191, v26, s79, v66
    v_cvt_pk_bf16_f32 v25, v188, v189
    v_lshlrev_b32 v188, 16, v25
    v_and_b32 v189, s78, v25
    v_pk_mul_f32 v[188:189], v[188:189], v[70:71] op_sel_hi:[1,0]
    v_cvt_pk_bf16_f32 v25, v188, v189
    v_dot2_f32_bf16 v192, v27, s77, v66
    v_dot2_f32_bf16 v193, v27, s79, v66
    v_cvt_pk_bf16_f32 v26, v190, v191
    v_lshlrev_b32 v190, 16, v26
    v_and_b32 v191, s78, v26
    v_pk_mul_f32 v[190:191], v[190:191], v[70:71] op_sel_hi:[1,0]
    v_cvt_pk_bf16_f32 v26, v190, v191
    v_dot2_f32_bf16 v186, v28, s77, v66
    v_dot2_f32_bf16 v187, v28, s79, v66
    v_cvt_pk_bf16_f32 v27, v192, v193
    v_lshlrev_b32 v192, 16, v27
    v_and_b32 v193, s78, v27
    v_pk_mul_f32 v[192:193], v[192:193], v[70:71] op_sel_hi:[1,0]
    v_cvt_pk_bf16_f32 v27, v192, v193
    ds_write_b128 v5, v[24:27] offset:256
    v_dot2_f32_bf16 v188, v29, s77, v66
    v_dot2_f32_bf16 v189, v29, s79, v66
    v_cvt_pk_bf16_f32 v28, v186, v187
    v_lshlrev_b32 v186, 16, v28
    v_and_b32 v187, s78, v28
    v_pk_mul_f32 v[186:187], v[186:187], v[70:71] op_sel_hi:[1,0]
    v_cvt_pk_bf16_f32 v28, v186, v187
    v_dot2_f32_bf16 v190, v30, s77, v66
    v_dot2_f32_bf16 v191, v30, s79, v66
    v_cvt_pk_bf16_f32 v29, v188, v189
    v_lshlrev_b32 v188, 16, v29
    v_and_b32 v189, s78, v29
    v_pk_mul_f32 v[188:189], v[188:189], v[70:71] op_sel_hi:[1,0]
    v_cvt_pk_bf16_f32 v29, v188, v189
    buffer_load_dwordx4 v[88:91], v7, s[40:43], s82 offen
    s_add_u32 s82, s82, 57344
    v_dot2_f32_bf16 v192, v31, s77, v66
    v_dot2_f32_bf16 v193, v31, s79, v66
    v_cvt_pk_bf16_f32 v30, v190, v191
    v_lshlrev_b32 v190, 16, v30
    v_and_b32 v191, s78, v30
    v_pk_mul_f32 v[190:191], v[190:191], v[70:71] op_sel_hi:[1,0]
    v_cvt_pk_bf16_f32 v30, v190, v191
    v_dot2_f32_bf16 v186, v32, s77, v66
    v_dot2_f32_bf16 v187, v32, s79, v66
    v_cvt_pk_bf16_f32 v31, v192, v193
    v_lshlrev_b32 v192, 16, v31
    v_and_b32 v193, s78, v31
    v_pk_mul_f32 v[192:193], v[192:193], v[70:71] op_sel_hi:[1,0]
    v_cvt_pk_bf16_f32 v31, v192, v193
    ds_write_b128 v5, v[28:31] offset:320
    v_dot2_f32_bf16 v188, v33, s77, v66
    v_dot2_f32_bf16 v189, v33, s79, v66
    v_cvt_pk_bf16_f32 v32, v186, v187
    v_lshlrev_b32 v186, 16, v32
    v_and_b32 v187, s78, v32
    v_pk_mul_f32 v[186:187], v[186:187], v[70:71] op_sel_hi:[1,0]
    v_cvt_pk_bf16_f32 v32, v186, v187
    v_dot2_f32_bf16 v190, v34, s77, v66
    v_dot2_f32_bf16 v191, v34, s79, v66
    v_cvt_pk_bf16_f32 v33, v188, v189
    v_lshlrev_b32 v188, 16, v33
    v_and_b32 v189, s78, v33
    v_pk_mul_f32 v[188:189], v[188:189], v[70:71] op_sel_hi:[1,0]
    v_cvt_pk_bf16_f32 v33, v188, v189
    v_dot2_f32_bf16 v192, v35, s77, v66
    v_dot2_f32_bf16 v193, v35, s79, v66
    v_cvt_pk_bf16_f32 v34, v190, v191
    v_lshlrev_b32 v190, 16, v34
    v_and_b32 v191, s78, v34
    v_pk_mul_f32 v[190:191], v[190:191], v[70:71] op_sel_hi:[1,0]
    v_cvt_pk_bf16_f32 v34, v190, v191
    v_dot2_f32_bf16 v186, v36, s77, v66
    v_dot2_f32_bf16 v187, v36, s79, v66
    v_cvt_pk_bf16_f32 v35, v192, v193
    v_lshlrev_b32 v192, 16, v35
    v_and_b32 v193, s78, v35
    v_pk_mul_f32 v[192:193], v[192:193], v[70:71] op_sel_hi:[1,0]
    v_cvt_pk_bf16_f32 v35, v192, v193
    ds_write_b128 v5, v[32:35] offset:384
    buffer_load_dwordx4 v[92:95], v7, s[40:43], s82 offen
    s_add_u32 s82, s82, 57344
    v_dot2_f32_bf16 v188, v37, s77, v66
    v_dot2_f32_bf16 v189, v37, s79, v66
    v_cvt_pk_bf16_f32 v36, v186, v187
    v_lshlrev_b32 v186, 16, v36
    v_and_b32 v187, s78, v36
    v_pk_mul_f32 v[186:187], v[186:187], v[70:71] op_sel_hi:[1,0]
    v_cvt_pk_bf16_f32 v36, v186, v187
    v_dot2_f32_bf16 v190, v38, s77, v66
    v_dot2_f32_bf16 v191, v38, s79, v66
    v_cvt_pk_bf16_f32 v37, v188, v189
    v_lshlrev_b32 v188, 16, v37
    v_and_b32 v189, s78, v37
    v_pk_mul_f32 v[188:189], v[188:189], v[70:71] op_sel_hi:[1,0]
    v_cvt_pk_bf16_f32 v37, v188, v189
    v_dot2_f32_bf16 v192, v39, s77, v66
    v_dot2_f32_bf16 v193, v39, s79, v66
    v_cvt_pk_bf16_f32 v38, v190, v191
    v_lshlrev_b32 v190, 16, v38
    v_and_b32 v191, s78, v38
    v_pk_mul_f32 v[190:191], v[190:191], v[70:71] op_sel_hi:[1,0]
    v_cvt_pk_bf16_f32 v38, v190, v191
    v_dot2_f32_bf16 v186, v40, s77, v66
    v_dot2_f32_bf16 v187, v40, s79, v66
    v_cvt_pk_bf16_f32 v39, v192, v193
    v_lshlrev_b32 v192, 16, v39
    v_and_b32 v193, s78, v39
    v_pk_mul_f32 v[192:193], v[192:193], v[70:71] op_sel_hi:[1,0]
    v_cvt_pk_bf16_f32 v39, v192, v193
    ds_write_b128 v5, v[36:39] offset:448
    v_dot2_f32_bf16 v188, v41, s77, v66
    v_dot2_f32_bf16 v189, v41, s79, v66
    v_cvt_pk_bf16_f32 v40, v186, v187
    v_lshlrev_b32 v186, 16, v40
    v_and_b32 v187, s78, v40
    v_pk_mul_f32 v[186:187], v[186:187], v[70:71] op_sel_hi:[1,0]
    v_cvt_pk_bf16_f32 v40, v186, v187
    buffer_load_dwordx4 v[96:99], v7, s[40:43], s82 offen
    s_add_u32 s82, s82, 57344
    v_dot2_f32_bf16 v190, v42, s77, v66
    v_dot2_f32_bf16 v191, v42, s79, v66
    v_cvt_pk_bf16_f32 v41, v188, v189
    v_lshlrev_b32 v188, 16, v41
    v_and_b32 v189, s78, v41
    v_pk_mul_f32 v[188:189], v[188:189], v[70:71] op_sel_hi:[1,0]
    v_cvt_pk_bf16_f32 v41, v188, v189
    v_dot2_f32_bf16 v192, v43, s77, v66
    v_dot2_f32_bf16 v193, v43, s79, v66
    v_cvt_pk_bf16_f32 v42, v190, v191
    v_lshlrev_b32 v190, 16, v42
    v_and_b32 v191, s78, v42
    v_pk_mul_f32 v[190:191], v[190:191], v[70:71] op_sel_hi:[1,0]
    v_cvt_pk_bf16_f32 v42, v190, v191
    v_dot2_f32_bf16 v186, v44, s77, v66
    v_dot2_f32_bf16 v187, v44, s79, v66
    v_cvt_pk_bf16_f32 v43, v192, v193
    v_lshlrev_b32 v192, 16, v43
    v_and_b32 v193, s78, v43
    v_pk_mul_f32 v[192:193], v[192:193], v[70:71] op_sel_hi:[1,0]
    v_cvt_pk_bf16_f32 v43, v192, v193
    ds_write_b128 v5, v[40:43] offset:512
    v_dot2_f32_bf16 v188, v45, s77, v66
    v_dot2_f32_bf16 v189, v45, s79, v66
    v_cvt_pk_bf16_f32 v44, v186, v187
    v_lshlrev_b32 v186, 16, v44
    v_and_b32 v187, s78, v44
    v_pk_mul_f32 v[186:187], v[186:187], v[70:71] op_sel_hi:[1,0]
    v_cvt_pk_bf16_f32 v44, v186, v187
    v_dot2_f32_bf16 v190, v46, s77, v66
    v_dot2_f32_bf16 v191, v46, s79, v66
    v_cvt_pk_bf16_f32 v45, v188, v189
    v_lshlrev_b32 v188, 16, v45
    v_and_b32 v189, s78, v45
    v_pk_mul_f32 v[188:189], v[188:189], v[70:71] op_sel_hi:[1,0]
    v_cvt_pk_bf16_f32 v45, v188, v189
    v_dot2_f32_bf16 v192, v47, s77, v66
    v_dot2_f32_bf16 v193, v47, s79, v66
    v_cvt_pk_bf16_f32 v46, v190, v191
    v_lshlrev_b32 v190, 16, v46
    v_and_b32 v191, s78, v46
    v_pk_mul_f32 v[190:191], v[190:191], v[70:71] op_sel_hi:[1,0]
    v_cvt_pk_bf16_f32 v46, v190, v191
    buffer_load_dwordx4 v[100:103], v7, s[40:43], s82 offen
    s_add_u32 s82, s82, 57344
    v_dot2_f32_bf16 v186, v48, s77, v66
    v_dot2_f32_bf16 v187, v48, s79, v66
    v_cvt_pk_bf16_f32 v47, v192, v193
    v_lshlrev_b32 v192, 16, v47
    v_and_b32 v193, s78, v47
    v_pk_mul_f32 v[192:193], v[192:193], v[70:71] op_sel_hi:[1,0]
    v_cvt_pk_bf16_f32 v47, v192, v193
    ds_write_b128 v5, v[44:47] offset:576
    v_dot2_f32_bf16 v188, v49, s77, v66
    v_dot2_f32_bf16 v189, v49, s79, v66
    v_cvt_pk_bf16_f32 v48, v186, v187
    v_lshlrev_b32 v186, 16, v48
    v_and_b32 v187, s78, v48
    v_pk_mul_f32 v[186:187], v[186:187], v[70:71] op_sel_hi:[1,0]
    v_cvt_pk_bf16_f32 v48, v186, v187
    v_dot2_f32_bf16 v190, v50, s77, v66
    v_dot2_f32_bf16 v191, v50, s79, v66
    v_cvt_pk_bf16_f32 v49, v188, v189
    v_lshlrev_b32 v188, 16, v49
    v_and_b32 v189, s78, v49
    v_pk_mul_f32 v[188:189], v[188:189], v[70:71] op_sel_hi:[1,0]
    v_cvt_pk_bf16_f32 v49, v188, v189
    v_dot2_f32_bf16 v192, v51, s77, v66
    v_dot2_f32_bf16 v193, v51, s79, v66
    v_cvt_pk_bf16_f32 v50, v190, v191
    v_lshlrev_b32 v190, 16, v50
    v_and_b32 v191, s78, v50
    v_pk_mul_f32 v[190:191], v[190:191], v[70:71] op_sel_hi:[1,0]
    v_cvt_pk_bf16_f32 v50, v190, v191
    v_dot2_f32_bf16 v186, v52, s77, v66
    v_dot2_f32_bf16 v187, v52, s79, v66
    v_cvt_pk_bf16_f32 v51, v192, v193
    v_lshlrev_b32 v192, 16, v51
    v_and_b32 v193, s78, v51
    v_pk_mul_f32 v[192:193], v[192:193], v[70:71] op_sel_hi:[1,0]
    v_cvt_pk_bf16_f32 v51, v192, v193
    ds_write_b128 v5, v[48:51] offset:640
    buffer_load_dwordx4 v[104:107], v7, s[40:43], s82 offen
    s_add_u32 s82, s82, 57344
    v_dot2_f32_bf16 v188, v53, s77, v66
    v_dot2_f32_bf16 v189, v53, s79, v66
    v_cvt_pk_bf16_f32 v52, v186, v187
    v_lshlrev_b32 v186, 16, v52
    v_and_b32 v187, s78, v52
    v_pk_mul_f32 v[186:187], v[186:187], v[70:71] op_sel_hi:[1,0]
    v_cvt_pk_bf16_f32 v52, v186, v187
    v_dot2_f32_bf16 v190, v54, s77, v66
    v_dot2_f32_bf16 v191, v54, s79, v66
    v_cvt_pk_bf16_f32 v53, v188, v189
    v_lshlrev_b32 v188, 16, v53
    v_and_b32 v189, s78, v53
    v_pk_mul_f32 v[188:189], v[188:189], v[70:71] op_sel_hi:[1,0]
    v_cvt_pk_bf16_f32 v53, v188, v189
    v_dot2_f32_bf16 v192, v55, s77, v66
    v_dot2_f32_bf16 v193, v55, s79, v66
    v_cvt_pk_bf16_f32 v54, v190, v191
    v_lshlrev_b32 v190, 16, v54
    v_and_b32 v191, s78, v54
    v_pk_mul_f32 v[190:191], v[190:191], v[70:71] op_sel_hi:[1,0]
    v_cvt_pk_bf16_f32 v54, v190, v191
    v_dot2_f32_bf16 v186, v56, s77, v66
    v_dot2_f32_bf16 v187, v56, s79, v66
    v_cvt_pk_bf16_f32 v55, v192, v193
    v_lshlrev_b32 v192, 16, v55
    v_and_b32 v193, s78, v55
    v_pk_mul_f32 v[192:193], v[192:193], v[70:71] op_sel_hi:[1,0]
    v_cvt_pk_bf16_f32 v55, v192, v193
    ds_write_b128 v5, v[52:55] offset:704
    v_dot2_f32_bf16 v188, v57, s77, v66
    v_dot2_f32_bf16 v189, v57, s79, v66
    v_cvt_pk_bf16_f32 v56, v186, v187
    v_lshlrev_b32 v186, 16, v56
    v_and_b32 v187, s78, v56
    v_pk_mul_f32 v[186:187], v[186:187], v[70:71] op_sel_hi:[1,0]
    v_cvt_pk_bf16_f32 v56, v186, v187
    v_dot2_f32_bf16 v190, v58, s77, v66
    v_dot2_f32_bf16 v191, v58, s79, v66
    v_cvt_pk_bf16_f32 v57, v188, v189
    v_lshlrev_b32 v188, 16, v57
    v_and_b32 v189, s78, v57
    v_pk_mul_f32 v[188:189], v[188:189], v[70:71] op_sel_hi:[1,0]
    v_cvt_pk_bf16_f32 v57, v188, v189
    buffer_load_dwordx4 v[108:111], v7, s[40:43], s82 offen
    s_add_u32 s82, s82, 57344
    v_dot2_f32_bf16 v192, v59, s77, v66
    v_dot2_f32_bf16 v193, v59, s79, v66
    v_cvt_pk_bf16_f32 v58, v190, v191
    v_lshlrev_b32 v190, 16, v58
    v_and_b32 v191, s78, v58
    v_pk_mul_f32 v[190:191], v[190:191], v[70:71] op_sel_hi:[1,0]
    v_cvt_pk_bf16_f32 v58, v190, v191
    v_dot2_f32_bf16 v186, v60, s77, v66
    v_dot2_f32_bf16 v187, v60, s79, v66
    v_cvt_pk_bf16_f32 v59, v192, v193
    v_lshlrev_b32 v192, 16, v59
    v_and_b32 v193, s78, v59
    v_pk_mul_f32 v[192:193], v[192:193], v[70:71] op_sel_hi:[1,0]
    v_cvt_pk_bf16_f32 v59, v192, v193
    ds_write_b128 v5, v[56:59] offset:768
    v_dot2_f32_bf16 v188, v61, s77, v66
    v_dot2_f32_bf16 v189, v61, s79, v66
    v_cvt_pk_bf16_f32 v60, v186, v187
    v_lshlrev_b32 v186, 16, v60
    v_and_b32 v187, s78, v60
    v_pk_mul_f32 v[186:187], v[186:187], v[70:71] op_sel_hi:[1,0]
    v_cvt_pk_bf16_f32 v60, v186, v187
    v_dot2_f32_bf16 v190, v62, s77, v66
    v_dot2_f32_bf16 v191, v62, s79, v66
    v_cvt_pk_bf16_f32 v61, v188, v189
    v_lshlrev_b32 v188, 16, v61
    v_and_b32 v189, s78, v61
    v_pk_mul_f32 v[188:189], v[188:189], v[70:71] op_sel_hi:[1,0]
    v_cvt_pk_bf16_f32 v61, v188, v189
    v_dot2_f32_bf16 v192, v63, s77, v66
    v_dot2_f32_bf16 v193, v63, s79, v66
    v_cvt_pk_bf16_f32 v62, v190, v191
    v_lshlrev_b32 v190, 16, v62
    v_and_b32 v191, s78, v62
    v_pk_mul_f32 v[190:191], v[190:191], v[70:71] op_sel_hi:[1,0]
    v_cvt_pk_bf16_f32 v62, v190, v191
    s_nop 0
    v_cvt_pk_bf16_f32 v63, v192, v193
    v_lshlrev_b32 v192, 16, v63
    v_and_b32_e64 v193, s78, v63
    v_pk_mul_f32 v[192:193], v[192:193], v[70:71] op_sel_hi:[1,0]
    v_cvt_pk_bf16_f32 v63, v192, v193
    ds_write_b128 v5, v[60:63] offset:832
    buffer_load_dwordx4 v[112:115], v7, s[40:43], s82 offen
    s_add_u32 s82, s82, 57344
    buffer_load_dwordx4 v[116:119], v7, s[40:43], s82 offen
    s_add_u32 s82, s82, 57344
    buffer_load_dwordx4 v[120:123], v7, s[40:43], s82 offen
    s_add_u32 s82, s82, 57344
    buffer_load_dwordx4 v[124:127], v7, s[40:43], s82 offen
    s_add_u32 s82, s82, 57344
    buffer_load_dwordx4 v[128:131], v7, s[40:43], s82 offen
    s_add_u32 s82, s82, 57344
    buffer_load_dwordx4 v[132:135], v7, s[40:43], s82 offen
    s_add_u32 s82, s82, 57344
    buffer_load_dwordx4 v[136:139], v7, s[40:43], s82 offen
    s_add_u32 s82, s82, 57344
    buffer_load_dwordx4 v[140:143], v7, s[40:43], s82 offen
    s_add_u32 s82, s82, 57344
    buffer_load_dwordx4 v[144:147], v7, s[40:43], s82 offen
    s_add_u32 s82, s82, 57344
    buffer_load_dwordx4 v[148:151], v7, s[40:43], s82 offen
    s_add_u32 s82, s82, 57344
    buffer_load_dwordx4 v[152:155], v7, s[40:43], s82 offen
    s_add_u32 s82, s82, 57344
    buffer_load_dwordx4 v[156:159], v7, s[40:43], s82 offen
    s_add_u32 s82, s82, 57344
    ds_read_b64_tr_b16 v[8:9], v194 offset:0
    ds_read_b64_tr_b16 v[10:11], v194 offset:3840
    ds_read_b64_tr_b16 v[12:13], v194 offset:64
    ds_read_b64_tr_b16 v[14:15], v194 offset:3904
    ds_read_b64_tr_b16 v[16:17], v194 offset:128
    ds_read_b64_tr_b16 v[18:19], v194 offset:3968
    ds_read_b64_tr_b16 v[20:21], v194 offset:192
    ds_read_b64_tr_b16 v[22:23], v194 offset:4032
    ds_read_b64_tr_b16 v[24:25], v194 offset:256
    ds_read_b64_tr_b16 v[26:27], v194 offset:4096
    ds_read_b64_tr_b16 v[28:29], v194 offset:320
    ds_read_b64_tr_b16 v[30:31], v194 offset:4160
    ds_read_b64_tr_b16 v[32:33], v194 offset:384
    ds_read_b64_tr_b16 v[34:35], v194 offset:4224
    ds_read_b64_tr_b16 v[36:37], v194 offset:448
    ds_read_b64_tr_b16 v[38:39], v194 offset:4288
    ds_read_b64_tr_b16 v[40:41], v194 offset:512
    ds_read_b64_tr_b16 v[42:43], v194 offset:4352
    ds_read_b64_tr_b16 v[44:45], v194 offset:576
    ds_read_b64_tr_b16 v[46:47], v194 offset:4416
    ds_read_b64_tr_b16 v[48:49], v194 offset:640
    ds_read_b64_tr_b16 v[50:51], v194 offset:4480
    ds_read_b64_tr_b16 v[52:53], v194 offset:704
    ds_read_b64_tr_b16 v[54:55], v194 offset:4544
    ds_read_b64_tr_b16 v[56:57], v194 offset:768
    ds_read_b64_tr_b16 v[58:59], v194 offset:4608
    ds_read_b64_tr_b16 v[60:61], v194 offset:832
    ds_read_b64_tr_b16 v[62:63], v194 offset:4672
    s_waitcnt lgkmcnt(15)
    ds_write_b128 v195, v[8:11] offset:0
    buffer_load_dwordx4 v[160:163], v7, s[40:43], s82 offen
    s_add_u32 s82, s82, 57344
    ds_write_b128 v195, v[12:15] offset:4608
    ds_write_b128 v195, v[16:19] offset:9216
    buffer_load_dwordx4 v[164:167], v7, s[40:43], s82 offen
    s_add_u32 s82, s82, 57344
    ds_write_b128 v195, v[20:23] offset:13824
    ds_write_b128 v195, v[24:27] offset:18432
    buffer_load_dwordx4 v[168:171], v7, s[40:43], s82 offen
    s_add_u32 s82, s82, 57344
    ds_write_b128 v195, v[28:31] offset:23040
    s_waitcnt lgkmcnt(15)
    ds_write_b128 v195, v[32:35] offset:27648
    ds_write_b128 v195, v[36:39] offset:32256
    buffer_load_dwordx4 v[172:175], v7, s[40:43], s82 offen
    s_add_u32 s82, s82, 57344
    ds_write_b128 v195, v[40:43] offset:36864
    s_waitcnt lgkmcnt(15)
    ds_write_b128 v195, v[44:47] offset:41472
    buffer_load_dwordx4 v[176:179], v7, s[40:43], s82 offen
    s_add_u32 s82, s82, 57344
    ds_write_b128 v195, v[48:51] offset:46080
    s_waitcnt lgkmcnt(15)
    ds_write_b128 v195, v[52:55] offset:50688
    buffer_load_dwordx4 v[180:183], v7, s[40:43], s82 offen
    s_add_u32 s82, s82, 57344
    s_waitcnt lgkmcnt(14)
    ds_write_b128 v195, v[56:59] offset:55296
    s_waitcnt lgkmcnt(13)
    ds_write_b128 v195, v[60:63] offset:59904
    global_load_dword v202, v203, s[32:33] sc1
    s_waitcnt lgkmcnt(0)
    s_barrier
    ds_read_b128 v[8:11], v196 offset:0
    ds_read_b128 v[12:15], v196 offset:1152
    ds_read_b128 v[16:19], v196 offset:2304
    ds_read_b128 v[20:23], v196 offset:3456
    ds_read_b128 v[24:27], v196 offset:4608
    ds_read_b128 v[28:31], v196 offset:5760
    ds_read_b128 v[32:35], v196 offset:6912
    ds_read_b128 v[36:39], v196 offset:8064
    ds_read_b128 v[40:43], v196 offset:9216
    ds_read_b128 v[44:47], v196 offset:10368
    ds_read_b128 v[48:51], v196 offset:11520
    ds_read_b128 v[52:55], v196 offset:12672
    ds_read_b128 v[56:59], v196 offset:13824
    ds_read_b128 v[60:63], v196 offset:14976
    s_waitcnt lgkmcnt(13)
    buffer_store_dwordx4 v[8:11], v197, s[48:51], s62 offen sc1
    s_add_u32 s62, s62, 33792
    s_waitcnt vmcnt(29)
    v_dot2_f32_bf16 v64, v72, s77, 0
    v_dot2_f32_bf16 v65, v72, s79, 0
    v_dot2_f32_bf16 v66, v73, s77, 0
    v_dot2_f32_bf16 v67, v73, s79, 0
    v_dot2_f32_bf16 v68, v74, s77, 0
    v_dot2_f32_bf16 v69, v74, s79, 0
    v_dot2_f32_bf16 v70, v75, s77, 0
    v_dot2_f32_bf16 v71, v75, s79, 0
    s_waitcnt vmcnt(28)
    v_dot2_f32_bf16 v64, v76, s77, v64
    v_dot2_f32_bf16 v65, v76, s79, v65
    v_dot2_f32_bf16 v66, v77, s77, v66
    v_dot2_f32_bf16 v67, v77, s79, v67
    v_dot2_f32_bf16 v68, v78, s77, v68
    v_dot2_f32_bf16 v69, v78, s79, v69
    v_dot2_f32_bf16 v70, v79, s77, v70
    v_dot2_f32_bf16 v71, v79, s79, v71
    s_waitcnt lgkmcnt(12)
    buffer_store_dwordx4 v[12:15], v197, s[48:51], s62 offen sc1
    s_add_u32 s62, s62, 33792
    s_waitcnt vmcnt(28)
    v_dot2_f32_bf16 v64, v80, s77, v64
    v_dot2_f32_bf16 v65, v80, s79, v65
    v_dot2_f32_bf16 v66, v81, s77, v66
    v_dot2_f32_bf16 v67, v81, s79, v67
    v_dot2_f32_bf16 v68, v82, s77, v68
    v_dot2_f32_bf16 v69, v82, s79, v69
    v_dot2_f32_bf16 v70, v83, s77, v70
    v_dot2_f32_bf16 v71, v83, s79, v71
    s_waitcnt vmcnt(27)
    v_dot2_f32_bf16 v64, v84, s77, v64
    v_dot2_f32_bf16 v65, v84, s79, v65
    v_dot2_f32_bf16 v66, v85, s77, v66
    v_dot2_f32_bf16 v67, v85, s79, v67
    v_dot2_f32_bf16 v68, v86, s77, v68
    v_dot2_f32_bf16 v69, v86, s79, v69
    v_dot2_f32_bf16 v70, v87, s77, v70
    v_dot2_f32_bf16 v71, v87, s79, v71
    s_waitcnt lgkmcnt(11)
    buffer_store_dwordx4 v[16:19], v197, s[48:51], s62 offen sc1
    s_add_u32 s62, s62, 33792
    s_waitcnt vmcnt(27)
    v_dot2_f32_bf16 v64, v88, s77, v64
    v_dot2_f32_bf16 v65, v88, s79, v65
    v_dot2_f32_bf16 v66, v89, s77, v66
    v_dot2_f32_bf16 v67, v89, s79, v67
    v_dot2_f32_bf16 v68, v90, s77, v68
    v_dot2_f32_bf16 v69, v90, s79, v69
    v_dot2_f32_bf16 v70, v91, s77, v70
    v_dot2_f32_bf16 v71, v91, s79, v71
    s_waitcnt vmcnt(26)
    v_dot2_f32_bf16 v64, v92, s77, v64
    v_dot2_f32_bf16 v65, v92, s79, v65
    v_dot2_f32_bf16 v66, v93, s77, v66
    v_dot2_f32_bf16 v67, v93, s79, v67
    v_dot2_f32_bf16 v68, v94, s77, v68
    v_dot2_f32_bf16 v69, v94, s79, v69
    v_dot2_f32_bf16 v70, v95, s77, v70
    v_dot2_f32_bf16 v71, v95, s79, v71
    s_waitcnt lgkmcnt(10)
    buffer_store_dwordx4 v[20:23], v197, s[48:51], s62 offen sc1
    s_add_u32 s62, s62, 33792
    s_waitcnt vmcnt(26)
    v_dot2_f32_bf16 v64, v96, s77, v64
    v_dot2_f32_bf16 v65, v96, s79, v65
    v_dot2_f32_bf16 v66, v97, s77, v66
    v_dot2_f32_bf16 v67, v97, s79, v67
    v_dot2_f32_bf16 v68, v98, s77, v68
    v_dot2_f32_bf16 v69, v98, s79, v69
    v_dot2_f32_bf16 v70, v99, s77, v70
    v_dot2_f32_bf16 v71, v99, s79, v71
    s_waitcnt vmcnt(25)
    v_dot2_f32_bf16 v64, v100, s77, v64
    v_dot2_f32_bf16 v65, v100, s79, v65
    v_dot2_f32_bf16 v66, v101, s77, v66
    v_dot2_f32_bf16 v67, v101, s79, v67
    v_dot2_f32_bf16 v68, v102, s77, v68
    v_dot2_f32_bf16 v69, v102, s79, v69
    v_dot2_f32_bf16 v70, v103, s77, v70
    v_dot2_f32_bf16 v71, v103, s79, v71
    s_waitcnt lgkmcnt(9)
    buffer_store_dwordx4 v[24:27], v197, s[48:51], s62 offen sc1
    s_add_u32 s62, s62, 33792
    s_waitcnt vmcnt(25)
    v_dot2_f32_bf16 v64, v104, s77, v64
    v_dot2_f32_bf16 v65, v104, s79, v65
    v_dot2_f32_bf16 v66, v105, s77, v66
    v_dot2_f32_bf16 v67, v105, s79, v67
    v_dot2_f32_bf16 v68, v106, s77, v68
    v_dot2_f32_bf16 v69, v106, s79, v69
    v_dot2_f32_bf16 v70, v107, s77, v70
    v_dot2_f32_bf16 v71, v107, s79, v71
    s_waitcnt vmcnt(24)
    v_dot2_f32_bf16 v64, v108, s77, v64
    v_dot2_f32_bf16 v65, v108, s79, v65
    v_dot2_f32_bf16 v66, v109, s77, v66
    v_dot2_f32_bf16 v67, v109, s79, v67
    v_dot2_f32_bf16 v68, v110, s77, v68
    v_dot2_f32_bf16 v69, v110, s79, v69
    v_dot2_f32_bf16 v70, v111, s77, v70
    v_dot2_f32_bf16 v71, v111, s79, v71
    s_waitcnt lgkmcnt(8)
    buffer_store_dwordx4 v[28:31], v197, s[48:51], s62 offen sc1
    s_add_u32 s62, s62, 33792
    s_waitcnt vmcnt(24)
    v_dot2_f32_bf16 v64, v112, s77, v64
    v_dot2_f32_bf16 v65, v112, s79, v65
    v_dot2_f32_bf16 v66, v113, s77, v66
    v_dot2_f32_bf16 v67, v113, s79, v67
    v_dot2_f32_bf16 v68, v114, s77, v68
    v_dot2_f32_bf16 v69, v114, s79, v69
    v_dot2_f32_bf16 v70, v115, s77, v70
    v_dot2_f32_bf16 v71, v115, s79, v71
    s_waitcnt vmcnt(23)
    v_dot2_f32_bf16 v64, v116, s77, v64
    v_dot2_f32_bf16 v65, v116, s79, v65
    v_dot2_f32_bf16 v66, v117, s77, v66
    v_dot2_f32_bf16 v67, v117, s79, v67
    v_dot2_f32_bf16 v68, v118, s77, v68
    v_dot2_f32_bf16 v69, v118, s79, v69
    v_dot2_f32_bf16 v70, v119, s77, v70
    v_dot2_f32_bf16 v71, v119, s79, v71
    s_waitcnt lgkmcnt(7)
    buffer_store_dwordx4 v[32:35], v197, s[48:51], s62 offen sc1
    s_add_u32 s62, s62, 33792
    s_waitcnt vmcnt(23)
    v_dot2_f32_bf16 v64, v120, s77, v64
    v_dot2_f32_bf16 v65, v120, s79, v65
    v_dot2_f32_bf16 v66, v121, s77, v66
    v_dot2_f32_bf16 v67, v121, s79, v67
    v_dot2_f32_bf16 v68, v122, s77, v68
    v_dot2_f32_bf16 v69, v122, s79, v69
    v_dot2_f32_bf16 v70, v123, s77, v70
    v_dot2_f32_bf16 v71, v123, s79, v71
    s_waitcnt vmcnt(22)
    v_dot2_f32_bf16 v64, v124, s77, v64
    v_dot2_f32_bf16 v65, v124, s79, v65
    v_dot2_f32_bf16 v66, v125, s77, v66
    v_dot2_f32_bf16 v67, v125, s79, v67
    v_dot2_f32_bf16 v68, v126, s77, v68
    v_dot2_f32_bf16 v69, v126, s79, v69
    v_dot2_f32_bf16 v70, v127, s77, v70
    v_dot2_f32_bf16 v71, v127, s79, v71
    s_waitcnt lgkmcnt(6)
    buffer_store_dwordx4 v[36:39], v197, s[48:51], s62 offen sc1
    s_add_u32 s62, s62, 33792
    s_waitcnt vmcnt(22)
    v_dot2_f32_bf16 v64, v128, s77, v64
    v_dot2_f32_bf16 v65, v128, s79, v65
    v_dot2_f32_bf16 v66, v129, s77, v66
    v_dot2_f32_bf16 v67, v129, s79, v67
    v_dot2_f32_bf16 v68, v130, s77, v68
    v_dot2_f32_bf16 v69, v130, s79, v69
    v_dot2_f32_bf16 v70, v131, s77, v70
    v_dot2_f32_bf16 v71, v131, s79, v71
    s_waitcnt vmcnt(21)
    v_dot2_f32_bf16 v64, v132, s77, v64
    v_dot2_f32_bf16 v65, v132, s79, v65
    v_dot2_f32_bf16 v66, v133, s77, v66
    v_dot2_f32_bf16 v67, v133, s79, v67
    v_dot2_f32_bf16 v68, v134, s77, v68
    v_dot2_f32_bf16 v69, v134, s79, v69
    v_dot2_f32_bf16 v70, v135, s77, v70
    v_dot2_f32_bf16 v71, v135, s79, v71
    s_waitcnt lgkmcnt(5)
    buffer_store_dwordx4 v[40:43], v197, s[48:51], s62 offen sc1
    s_add_u32 s62, s62, 33792
    s_waitcnt vmcnt(21)
    v_dot2_f32_bf16 v64, v136, s77, v64
    v_dot2_f32_bf16 v65, v136, s79, v65
    v_dot2_f32_bf16 v66, v137, s77, v66
    v_dot2_f32_bf16 v67, v137, s79, v67
    v_dot2_f32_bf16 v68, v138, s77, v68
    v_dot2_f32_bf16 v69, v138, s79, v69
    v_dot2_f32_bf16 v70, v139, s77, v70
    v_dot2_f32_bf16 v71, v139, s79, v71
    s_waitcnt vmcnt(20)
    v_dot2_f32_bf16 v64, v140, s77, v64
    v_dot2_f32_bf16 v65, v140, s79, v65
    v_dot2_f32_bf16 v66, v141, s77, v66
    v_dot2_f32_bf16 v67, v141, s79, v67
    v_dot2_f32_bf16 v68, v142, s77, v68
    v_dot2_f32_bf16 v69, v142, s79, v69
    v_dot2_f32_bf16 v70, v143, s77, v70
    v_dot2_f32_bf16 v71, v143, s79, v71
    s_waitcnt lgkmcnt(4)
    buffer_store_dwordx4 v[44:47], v197, s[48:51], s62 offen sc1
    s_add_u32 s62, s62, 33792
    s_waitcnt vmcnt(20)
    v_dot2_f32_bf16 v64, v144, s77, v64
    v_dot2_f32_bf16 v65, v144, s79, v65
    v_dot2_f32_bf16 v66, v145, s77, v66
    v_dot2_f32_bf16 v67, v145, s79, v67
    v_dot2_f32_bf16 v68, v146, s77, v68
    v_dot2_f32_bf16 v69, v146, s79, v69
    v_dot2_f32_bf16 v70, v147, s77, v70
    v_dot2_f32_bf16 v71, v147, s79, v71
    s_waitcnt vmcnt(19)
    v_dot2_f32_bf16 v64, v148, s77, v64
    v_dot2_f32_bf16 v65, v148, s79, v65
    v_dot2_f32_bf16 v66, v149, s77, v66
    v_dot2_f32_bf16 v67, v149, s79, v67
    v_dot2_f32_bf16 v68, v150, s77, v68
    v_dot2_f32_bf16 v69, v150, s79, v69
    v_dot2_f32_bf16 v70, v151, s77, v70
    v_dot2_f32_bf16 v71, v151, s79, v71
    s_waitcnt lgkmcnt(3)
    buffer_store_dwordx4 v[48:51], v197, s[48:51], s62 offen sc1
    s_add_u32 s62, s62, 33792
    s_waitcnt vmcnt(19)
    v_dot2_f32_bf16 v64, v152, s77, v64
    v_dot2_f32_bf16 v65, v152, s79, v65
    v_dot2_f32_bf16 v66, v153, s77, v66
    v_dot2_f32_bf16 v67, v153, s79, v67
    v_dot2_f32_bf16 v68, v154, s77, v68
    v_dot2_f32_bf16 v69, v154, s79, v69
    v_dot2_f32_bf16 v70, v155, s77, v70
    v_dot2_f32_bf16 v71, v155, s79, v71
    s_waitcnt vmcnt(18)
    v_dot2_f32_bf16 v64, v156, s77, v64
    v_dot2_f32_bf16 v65, v156, s79, v65
    v_dot2_f32_bf16 v66, v157, s77, v66
    v_dot2_f32_bf16 v67, v157, s79, v67
    v_dot2_f32_bf16 v68, v158, s77, v68
    v_dot2_f32_bf16 v69, v158, s79, v69
    v_dot2_f32_bf16 v70, v159, s77, v70
    v_dot2_f32_bf16 v71, v159, s79, v71
    s_waitcnt lgkmcnt(2)
    buffer_store_dwordx4 v[52:55], v197, s[48:51], s62 offen sc1
    s_add_u32 s62, s62, 33792
    s_waitcnt vmcnt(18)
    v_dot2_f32_bf16 v64, v160, s77, v64
    v_dot2_f32_bf16 v65, v160, s79, v65
    v_dot2_f32_bf16 v66, v161, s77, v66
    v_dot2_f32_bf16 v67, v161, s79, v67
    v_dot2_f32_bf16 v68, v162, s77, v68
    v_dot2_f32_bf16 v69, v162, s79, v69
    v_dot2_f32_bf16 v70, v163, s77, v70
    v_dot2_f32_bf16 v71, v163, s79, v71
    s_waitcnt vmcnt(17)
    v_dot2_f32_bf16 v64, v164, s77, v64
    v_dot2_f32_bf16 v65, v164, s79, v65
    v_dot2_f32_bf16 v66, v165, s77, v66
    v_dot2_f32_bf16 v67, v165, s79, v67
    v_dot2_f32_bf16 v68, v166, s77, v68
    v_dot2_f32_bf16 v69, v166, s79, v69
    v_dot2_f32_bf16 v70, v167, s77, v70
    v_dot2_f32_bf16 v71, v167, s79, v71
    s_waitcnt lgkmcnt(1)
    buffer_store_dwordx4 v[56:59], v197, s[48:51], s62 offen sc1
    s_add_u32 s62, s62, 33792
    s_waitcnt vmcnt(17)
    v_dot2_f32_bf16 v64, v168, s77, v64
    v_dot2_f32_bf16 v65, v168, s79, v65
    v_dot2_f32_bf16 v66, v169, s77, v66
    v_dot2_f32_bf16 v67, v169, s79, v67
    v_dot2_f32_bf16 v68, v170, s77, v68
    v_dot2_f32_bf16 v69, v170, s79, v69
    v_dot2_f32_bf16 v70, v171, s77, v70
    v_dot2_f32_bf16 v71, v171, s79, v71
    s_waitcnt vmcnt(16)
    v_dot2_f32_bf16 v64, v172, s77, v64
    v_dot2_f32_bf16 v65, v172, s79, v65
    v_dot2_f32_bf16 v66, v173, s77, v66
    v_dot2_f32_bf16 v67, v173, s79, v67
    v_dot2_f32_bf16 v68, v174, s77, v68
    v_dot2_f32_bf16 v69, v174, s79, v69
    v_dot2_f32_bf16 v70, v175, s77, v70
    v_dot2_f32_bf16 v71, v175, s79, v71
    s_waitcnt lgkmcnt(0)
    buffer_store_dwordx4 v[60:63], v197, s[48:51], s62 offen sc1
    s_add_u32 s62, s62, 33792
    s_waitcnt vmcnt(16)
    v_dot2_f32_bf16 v64, v176, s77, v64
    v_dot2_f32_bf16 v65, v176, s79, v65
    v_dot2_f32_bf16 v66, v177, s77, v66
    v_dot2_f32_bf16 v67, v177, s79, v67
    v_dot2_f32_bf16 v68, v178, s77, v68
    v_dot2_f32_bf16 v69, v178, s79, v69
    v_dot2_f32_bf16 v70, v179, s77, v70
    v_dot2_f32_bf16 v71, v179, s79, v71
    s_waitcnt vmcnt(15)
    v_dot2_f32_bf16 v64, v180, s77, v64
    v_dot2_f32_bf16 v65, v180, s79, v65
    v_dot2_f32_bf16 v66, v181, s77, v66
    v_dot2_f32_bf16 v67, v181, s79, v67
    v_dot2_f32_bf16 v68, v182, s77, v68
    v_dot2_f32_bf16 v69, v182, s79, v69
    v_dot2_f32_bf16 v70, v183, s77, v70
    v_dot2_f32_bf16 v71, v183, s79, v71
    ds_write_b128 v6, v[64:67]
    s_nop 1
    ds_write_b128 v6, v[68:71] offset:16
    s_waitcnt lgkmcnt(0)
    s_barrier
    ds_read_b32 v72, v198 offset:0
    ds_read_b32 v73, v198 offset:512
    ds_read_b32 v74, v198 offset:1024
    ds_read_b32 v75, v198 offset:1536
    ds_read_b32 v76, v198 offset:2048
    ds_read_b32 v77, v198 offset:2560
    ds_read_b32 v78, v198 offset:3072
    ds_read_b32 v79, v198 offset:3584
    ds_read_b32 v80, v198 offset:4096
    ds_read_b32 v81, v198 offset:4608
    ds_read_b32 v82, v198 offset:5120
    ds_read_b32 v83, v198 offset:5632
    ds_read_b32 v84, v198 offset:6144
    ds_read_b32 v85, v198 offset:6656
    ds_read_b32 v86, v198 offset:7168
    ds_read_b32 v87, v198 offset:7680
    s_waitcnt lgkmcnt(7)
    v_add_f32 v72, v72, v80
    s_waitcnt lgkmcnt(6)
    v_add_f32 v73, v73, v81
    s_waitcnt lgkmcnt(5)
    v_add_f32 v74, v74, v82
    s_waitcnt lgkmcnt(4)
    v_add_f32 v75, v75, v83
    s_waitcnt lgkmcnt(3)
    v_add_f32 v76, v76, v84
    s_waitcnt lgkmcnt(2)
    v_add_f32 v77, v77, v85
    s_waitcnt lgkmcnt(1)
    v_add_f32 v78, v78, v86
    s_waitcnt lgkmcnt(0)
    v_add_f32 v79, v79, v87
    v_add_f32 v72, v72, v76
    v_add_f32 v73, v73, v77
    v_add_f32 v74, v74, v78
    v_add_f32 v75, v75, v79
    v_add_f32 v72, v72, v74
    v_add_f32 v73, v73, v75
    v_add_f32 v72, v72, v73
    v_cvt_pk_bf16_f32 v73, v72, v72
    v_and_b32 v73, s78, v73
    v_sub_f32 v74, v72, v73
    v_cvt_pk_bf16_f32 v73, v73, v74
    v_lshlrev_b32_e64 v2, 4, v3
    v_lshrrev_b32 v1, 4, v255
    v_lshl_add_u32 v2, v1, 2, v2
    s_lshr_b32 s74, s61, 1
    s_lshl_b32 s74, s74, 1
    s_add_u32 s74, s74, s56
    s_lshl_b32 s74, s74, 1
    s_and_b32 s75, s61, 1
    s_add_u32 s74, s74, s75
    s_lshl_b32 s74, s74, 8
    s_add_u32 s74, s74, 11550720
    s_cmp_lt_u32 s60, 14
    s_cselect_b32 s74, s74, 12058624
    s_cmp_lt_u32 s56, 2
    s_cselect_b32 s74, s74, 12058624
    buffer_store_dword v73, v2, s[48:51], s74 offen sc1
    s_waitcnt vmcnt(15)
    v_cmp_eq_u32 vcc, 0, v202
    s_cbranch_vccnz L_slow_hnc
L_back_hnc:
    v_mul_u32_u24 v1, 1024, v255
    s_lshl_b32 s74, s59, 2
    s_add_u32 s74, s74, 11698176
    s_waitcnt vmcnt(0)
    s_barrier
    s_cmp_eq_u32 s56, 0
    s_cbranch_scc0 L_hdone
    s_mov_b64 exec, 0xff
    buffer_store_dword v202, v1, s[48:51], s74 offen sc1
    s_mov_b64 exec, -1
L_hdone:
L_end:
    s_endpgm
L_slow_nc:
    s_mov_b32 s68, 0
L_retry_nc:
    s_add_u32 s68, s68, 1
    s_cmp_gt_u32 s68, 200000
    s_cbranch_scc1 L_back_nc
    global_load_dword v224, v225, s[32:33] sc1
    s_waitcnt vmcnt(0)
    v_cmp_eq_u32 vcc, 0, v224
    s_cbranch_vccnz L_retry_nc
    s_branch L_back_nc
L_slow_fl:
    s_mov_b32 s68, 0
L_retry_fl:
    s_add_u32 s68, s68, 1
    s_cmp_gt_u32 s68, 200000
    s_cbranch_scc1 L_back_fl
    buffer_load_dword v213, v210, s[48:51], s80 offen sc1
    s_waitcnt vmcnt(0)
    v_cmp_ne_u32 vcc, s64, v213
    s_cbranch_vccnz L_retry_fl
    s_branch L_back_fl
L_slow_fh:
    s_mov_b32 s68, 0
L_retry_fh:
    s_add_u32 s68, s68, 1
    s_cmp_gt_u32 s68, 200000
    s_cbranch_scc1 L_back_fh
    buffer_load_dword v213, v217, s[48:51], s93 offen sc1
    s_waitcnt vmcnt(0)
    v_cmp_ne_u32 vcc, s64, v213
    s_cbranch_vccnz L_retry_fh
    s_branch L_back_fh
L_slow_fy:
    s_mov_b32 s68, 0
L_retry_fy:
    s_add_u32 s68, s68, 1
    s_cmp_gt_u32 s68, 200000
    s_cbranch_scc1 L_back_fy
    buffer_load_dword v213, v210, s[48:51], s80 offen sc1
    s_waitcnt vmcnt(0)
    v_cmp_ne_u32 vcc, s64, v213
    s_cbranch_vccnz L_retry_fy
    s_branch L_back_fy
L_slow_hnc:
    s_mov_b32 s68, 0
L_retry_hnc:
    s_add_u32 s68, s68, 1
    s_cmp_gt_u32 s68, 200000
    s_cbranch_scc1 L_back_hnc
    global_load_dword v202, v203, s[32:33] sc1
    s_waitcnt vmcnt(0)
    v_cmp_eq_u32 vcc, 0, v202
    s_cbranch_vccnz L_retry_hnc
    s_branch L_back_hnc
L_codeend:
    s_endpgm

.section .rodata,"a"
.p2align 6
.amdhsa_kernel parallel_sum__ssm_conv_s4__glu_gated_reglu__prompt_kernel
  .amdhsa_next_free_vgpr 512
  .amdhsa_next_free_sgpr 102
  .amdhsa_accum_offset 256
  .amdhsa_group_segment_fixed_size 0
  .amdhsa_kernarg_size 128
  .amdhsa_user_sgpr_count 2
  .amdhsa_user_sgpr_kernarg_segment_ptr 1
  .amdhsa_system_sgpr_workgroup_id_x 1
.end_amdhsa_kernel
```
